```python
import torch

def _softmax(x, axis=-1):
    return torch.softmax(x, dim=axis)
def _gelu(x):
    return torch.nn.functional.gelu(x, approximate="tanh")
def _silu(x):
    return torch.nn.functional.silu(x)
def _sigmoid(x):
    return torch.sigmoid(x)
def _layernorm(x, axis=-1, eps=1e-5):
    m = x.mean(dim=axis, keepdim=True)
    v = x.var(dim=axis, keepdim=True, unbiased=False)
    return (x - m) / torch.sqrt(v + eps)
def _scatter_add(tgt, idx, src, axis=0):
    return tgt.clone().index_add_(axis, idx, src)
def _segment_sum(src, seg, n):
    out = torch.zeros((n,) + src.shape[1:], dtype=src.dtype)
    return out.index_add_(0, seg, src)
def _pad(x, pw):
    flat = tuple(v for pair in reversed(pw) for v in pair)
    return torch.nn.functional.pad(x, flat)

kernel_name = 'concat_heads__compressed_kv_cla__compressed_kv_cla__decode'

def setup_inputs():

    _w = (lambda a: (lambda t: t.to(torch.bfloat16) if t.is_floating_point() else t)(torch.as_tensor(a)))
    def _A_setup():
        B, H, Sq, Sk, D, M = 4, 32, 1, 4096, 128, 512
        Dc = 4 * D
        return {
            "x": _w((lambda *s: torch.randn(*s, dtype=torch.bfloat16) * 3.2)(B, Sq, M)),
            "c_kv": _w((lambda *s: torch.randn(*s, dtype=torch.bfloat16) * 0.05)(B, Sk, Dc)),
            "w_q": _w((lambda *s: torch.randn(*s, dtype=torch.bfloat16) * 3.2)(M, H, D) * (M ** -0.5)),
            "w_uk": _w((lambda *s: torch.randn(*s, dtype=torch.bfloat16) * 3.2)(Dc, H, D) * (Dc ** -0.5)),
            "w_uv": _w((lambda *s: torch.randn(*s, dtype=torch.bfloat16) * 0.05)(Dc, H, D) * (Dc ** -0.5)),
            "w_o": _w((lambda *s: torch.randn(*s, dtype=torch.bfloat16) * 0.05)(H, D, M) * ((H * D) ** -0.5)),
        }
    _A_in = _A_setup()

    def _B_setup():
        B, H, Sq, Sk, D, M = 4, 32, 1, 4096, 128, 512
        Dc = 4 * D
        return {
            "x": _w((lambda *s: torch.randn(*s, dtype=torch.bfloat16) * 3.2)(B, Sq, M)),
            "c_kv": _w((lambda *s: torch.randn(*s, dtype=torch.bfloat16) * 0.05)(B, Sk, Dc)),
            "w_q": _w((lambda *s: torch.randn(*s, dtype=torch.bfloat16) * 3.2)(M, H, D) * (M ** -0.5)),
            "w_uk": _w((lambda *s: torch.randn(*s, dtype=torch.bfloat16) * 3.2)(Dc, H, D) * (Dc ** -0.5)),
            "w_uv": _w((lambda *s: torch.randn(*s, dtype=torch.bfloat16) * 0.05)(Dc, H, D) * (Dc ** -0.5)),
            "w_o": _w((lambda *s: torch.randn(*s, dtype=torch.bfloat16) * 0.05)(H, D, M) * ((H * D) ** -0.5)),
        }
    _B_in = _B_setup()

    return {
        "A_x": _A_in["x"],
        "A_c_kv": _A_in["c_kv"],
        "A_w_q": _A_in["w_q"],
        "A_w_uk": _A_in["w_uk"],
        "A_w_uv": _A_in["w_uv"],
        "A_w_o": _A_in["w_o"],
        "B_x": _B_in["x"],
        "B_c_kv": _B_in["c_kv"],
        "B_w_q": _B_in["w_q"],
        "B_w_uk": _B_in["w_uk"],
        "B_w_uv": _B_in["w_uv"],
        "B_w_o": _B_in["w_o"],
    }

def reference(A_x, A_c_kv, A_w_q, A_w_uk, A_w_uv, A_w_o, B_x, B_c_kv, B_w_q, B_w_uk, B_w_uv, B_w_o):
    def _A_ref(x, c_kv, w_q, w_uk, w_uv, w_o):
        B, Sq, M = x.shape[0], x.shape[1], x.shape[2]
        Sk = c_kv.shape[1]
        H, D = w_q.shape[1], w_q.shape[2]
        q = torch.einsum("bqm,mhd->bhqd", x, w_q)
        k = torch.einsum("bkc,chd->bhkd", c_kv, w_uk)
        v = torch.einsum("bkc,chd->bhkd", c_kv, w_uv)
        scores = torch.einsum("bhqd,bhkd->bhqk", q, k) * (D ** -0.5)
        off = Sk - Sq
        qi = torch.arange(Sq)[:, None]
        kj = torch.arange(Sk)[None, :]
        cmask = kj <= (qi + off)
        scores = torch.where(cmask[None, None], scores, -1e9)
        p = _softmax(scores, axis=-1)
        ctx = torch.einsum("bhqk,bhkd->bhqd", p, v)
        return torch.einsum("bhqd,hdm->bqm", ctx, w_o)

    def _B_ref(x, c_kv, w_q, w_uk, w_uv, w_o):
        B, Sq, M = x.shape[0], x.shape[1], x.shape[2]
        Sk = c_kv.shape[1]
        H, D = w_q.shape[1], w_q.shape[2]
        q = torch.einsum("bqm,mhd->bhqd", x, w_q)
        k = torch.einsum("bkc,chd->bhkd", c_kv, w_uk)
        v = torch.einsum("bkc,chd->bhkd", c_kv, w_uv)
        scores = torch.einsum("bhqd,bhkd->bhqk", q, k) * (D ** -0.5)
        off = Sk - Sq
        qi = torch.arange(Sq)[:, None]
        kj = torch.arange(Sk)[None, :]
        cmask = kj <= (qi + off)
        scores = torch.where(cmask[None, None], scores, -1e9)
        p = _softmax(scores, axis=-1)
        ctx = torch.einsum("bhqk,bhkd->bhqd", p, v)
        return torch.einsum("bhqd,hdm->bqm", ctx, w_o)

    a = _A_ref(A_x, A_c_kv, A_w_q, A_w_uk, A_w_uv, A_w_o)
    b = _B_ref(B_x, B_c_kv, B_w_q, B_w_uk, B_w_uv, B_w_o)
    return torch.concatenate([a, b], axis=-1)
```

```asm
; @launch grid=(256,1,1) block=(256,1,1) lds=163840
.amdgcn_target "amdgcn-amd-amdhsa--gfx950"
.text
.globl concat_heads__compressed_kv_cla__compressed_kv_cla__decode_kernel
.p2align 8
.type concat_heads__compressed_kv_cla__compressed_kv_cla__decode_kernel,@function
concat_heads__compressed_kv_cla__compressed_kv_cla__decode_kernel:
    s_cmp_ge_u32 s2, 256
    s_cbranch_scc1 L_end
    s_load_dwordx16 s[8:23], s[0:1], 0
    s_load_dwordx8 s[24:31], s[0:1], 64
    s_load_dwordx4 s[32:35], s[0:1], 96
    s_load_dwordx2 s[36:37], s[0:1], 112
    v_and_b32 v1, 63, v0
    v_lshrrev_b32 v2, 6, v0
    s_and_b32 s72, s2, 7
    v_readfirstlane_b32 s78, v2
    s_lshr_b32 s73, s2, 3
    s_lshr_b32 s74, s72, 2
    s_and_b32 s75, s72, 3
    s_xor_b32 s76, s74, 1
    s_and_b32 s77, s73, 3
    s_lshl_b32 s7, s75, 3
    s_lshr_b32 s82, s73, 2
    s_add_u32 s7, s7, s82
    s_lshl_b32 s89, s76, 5
    s_add_u32 s89, s89, s7
    s_mov_b32 s101, 0xffff0000
    s_mov_b32 s94, 0x3e0293ee
    v_lshrrev_b32 v2, 4, v1
    v_and_b32 v3, 15, v1
    v_lshlrev_b32 v6, 4, v1
    v_lshlrev_b32 v16, 2, v2
    v_xor_b32 v16, v16, v3
    v_xor_b32 v16, s78, v16
    v_lshlrev_b32 v16, 4, v16
    v_lshl_add_u32 v4, v2, 13, v16
    v_lshl_add_u32 v5, v2, 10, v16
    s_waitcnt lgkmcnt(0)
    s_mov_b32 s64, s36
    s_mov_b32 s65, s37
    s_mov_b32 s66, 0x10000000
    s_mov_b32 s67, 0x00020000
    s_mov_b32 s4, s36
    s_mov_b32 s5, s37
    s_add_u32 s38, s36, 0
    s_addc_u32 s39, s37, 0
    s_load_dword s80, s[38:39], 0
    s_cmp_eq_u32 s76, 0
    s_cselect_b32 s44, s12, s24
    s_cselect_b32 s45, s13, s25
    s_mov_b32 s46, 4194304
    s_mov_b32 s47, 0x00020000
    s_cmp_eq_u32 s76, 0
    s_cselect_b32 s40, s8, s20
    s_cselect_b32 s41, s9, s21
    s_mov_b32 s42, 4096
    s_mov_b32 s43, 0x00020000
    s_lshl_b32 s82, s77, 20
    s_lshl_b32 s83, s7, 8
    s_add_u32 s95, s82, s83
    s_lshl_b32 s83, s78, 15
    s_add_u32 s82, s95, s83
    s_lshl_b32 s84, s78, 10
    s_add_u32 s84, s84, 98304
    s_mov_b32 m0, s84
    s_add_u32 s84, s84, 4096
    buffer_load_dwordx4 v4, s[44:47], s82 offen nt lds
    s_add_u32 s82, s82, 131072
    s_mov_b32 m0, s84
    s_add_u32 s84, s84, 4096
    buffer_load_dwordx4 v4, s[44:47], s82 offen nt lds
    s_add_u32 s82, s82, 131072
    s_mov_b32 m0, s84
    s_add_u32 s84, s84, 4096
    buffer_load_dwordx4 v4, s[44:47], s82 offen nt lds
    s_add_u32 s82, s82, 131072
    s_mov_b32 m0, s84
    s_add_u32 s84, s84, 4096
    buffer_load_dwordx4 v4, s[44:47], s82 offen nt lds
    s_add_u32 s82, s82, 131072
    s_mov_b32 m0, s84
    s_add_u32 s84, s84, 4096
    buffer_load_dwordx4 v4, s[44:47], s82 offen nt lds
    s_add_u32 s82, s82, 131072
    s_mov_b32 m0, s84
    s_add_u32 s84, s84, 4096
    buffer_load_dwordx4 v4, s[44:47], s82 offen nt lds
    s_add_u32 s82, s82, 131072
    s_mov_b32 m0, s84
    s_add_u32 s84, s84, 4096
    buffer_load_dwordx4 v4, s[44:47], s82 offen nt lds
    s_add_u32 s82, s82, 131072
    s_mov_b32 m0, s84
    s_add_u32 s84, s84, 4096
    buffer_load_dwordx4 v4, s[44:47], s82 offen nt lds
    v_and_b32 v16, 3, v1
    v_lshlrev_b32 v17, 10, v16
    v_lshl_add_u32 v17, v2, 4, v17
    s_lshl_b32 s82, s77, 8
    buffer_load_dwordx4 v[64:67], v17, s[40:43], s82 offen offset:0 nt
    buffer_load_dwordx4 v[68:71], v17, s[40:43], s82 offen offset:64 nt
    buffer_load_dwordx4 v[72:75], v17, s[40:43], s82 offen offset:128 nt
    buffer_load_dwordx4 v[76:79], v17, s[40:43], s82 offen offset:192 nt
    v_lshlrev_b32 v200, 3, v1
    s_lshl_b32 s98, s89, 13
    s_lshl_b32 s99, s78, 9
    s_add_u32 s98, s98, s99
    s_add_u32 s98, s98, 17301504
    s_add_u32 s99, s98, 4096
    buffer_load_dwordx2 v[192:193], v200, s[64:67], s98 offen offset:0 sc1
    buffer_load_dwordx2 v[194:195], v200, s[64:67], s98 offen offset:2048 sc1
    buffer_load_dwordx2 v[196:197], v200, s[64:67], s99 offen offset:0 sc1
    buffer_load_dwordx2 v[198:199], v200, s[64:67], s99 offen offset:2048 sc1
    v_lshlrev_b32 v12, 8, v16
    v_lshl_add_u32 v12, v2, 4, v12
    s_cmp_eq_u32 s76, 0
    s_cselect_b32 s48, s14, s26
    s_cselect_b32 s49, s15, s27
    s_mov_b32 s50, 4194304
    s_mov_b32 s51, 0x00020000
    v_lshlrev_b32 v14, 13, v3
    v_lshl_add_u32 v14, v2, 4, v14
    s_cmp_eq_u32 s74, 0
    s_cselect_b32 s60, s10, s22
    s_cselect_b32 s61, s11, s23
    s_mov_b32 s62, 16777216
    s_mov_b32 s63, 0x00020000
    s_cmp_eq_u32 s76, 0
    s_cselect_b32 s52, s16, s28
    s_cselect_b32 s53, s17, s29
    s_mov_b32 s54, 4194304
    s_mov_b32 s55, 0x00020000
    s_cmp_eq_u32 s76, 0
    s_cselect_b32 s56, s18, s30
    s_cselect_b32 s57, s19, s31
    s_mov_b32 s58, 4194304
    s_mov_b32 s59, 0x00020000
    s_mov_b32 s68, s32
    s_mov_b32 s69, s33
    s_mov_b32 s70, 8192
    s_mov_b32 s71, 0x00020000
    s_lshl_b32 s86, s75, 22
    s_lshl_b32 s82, s73, 17
    s_add_u32 s86, s86, s82
    s_lshl_b32 s82, s78, 12
    s_add_u32 s86, s86, s82
    s_lshl_b32 s87, s78, 10
    s_mov_b32 s88, 0
    s_mov_b32 s100, 0
    v_lshrrev_b32 v16, 2, v3
    v_and_b32 v17, 3, v3
    v_lshrrev_b32 v18, 1, v17
    v_and_b32 v17, 1, v17
    v_xor_b32 v19, s78, v16
    v_lshl_add_u32 v20, v2, 3, v16
    v_lshlrev_b32 v21, 1, v2
    v_add_u32 v21, 0, v21
    v_and_b32 v21, 3, v21
    v_add_u32 v22, 0, v18
    v_xor_b32 v21, v21, v22
    v_lshl_add_u32 v21, v19, 2, v21
    v_lshlrev_b32 v21, 4, v21
    v_lshl_add_u32 v21, v17, 3, v21
    v_add_u32 v22, 0, v20
    v_lshl_add_u32 v8, v22, 8, v21
    v_lshlrev_b32 v21, 1, v2
    v_add_u32 v21, 1, v21
    v_and_b32 v21, 3, v21
    v_add_u32 v22, 0, v18
    v_xor_b32 v21, v21, v22
    v_lshl_add_u32 v21, v19, 2, v21
    v_lshlrev_b32 v21, 4, v21
    v_lshl_add_u32 v21, v17, 3, v21
    v_add_u32 v22, 4, v20
    v_lshl_add_u32 v9, v22, 8, v21
    v_lshlrev_b32 v21, 1, v2
    v_add_u32 v21, 0, v21
    v_and_b32 v21, 3, v21
    v_add_u32 v22, 2, v18
    v_xor_b32 v21, v21, v22
    v_lshl_add_u32 v21, v19, 2, v21
    v_lshlrev_b32 v21, 4, v21
    v_lshl_add_u32 v21, v17, 3, v21
    v_add_u32 v22, 0, v20
    v_lshl_add_u32 v10, v22, 8, v21
    v_lshlrev_b32 v21, 1, v2
    v_add_u32 v21, 1, v21
    v_and_b32 v21, 3, v21
    v_add_u32 v22, 2, v18
    v_xor_b32 v21, v21, v22
    v_lshl_add_u32 v21, v19, 2, v21
    v_lshlrev_b32 v21, 4, v21
    v_lshl_add_u32 v21, v17, 3, v21
    v_add_u32 v22, 4, v20
    v_lshl_add_u32 v11, v22, 8, v21
    v_and_b32 v13, 3, v3
    v_lshlrev_b32 v13, 9, v13
    v_lshl_add_u32 v13, v2, 4, v13
    v_lshrrev_b32 v22, 2, v3
    v_lshl_add_u32 v13, v22, 6, v13
    s_lshl_b32 s83, s78, 15
    s_add_u32 s82, s95, s83
    s_lshl_b32 s84, s78, 10
    s_add_u32 s84, s84, 65536
    s_waitcnt vmcnt(15)
    s_mov_b32 m0, s84
    s_add_u32 s84, s84, 4096
    buffer_load_dwordx4 v4, s[48:51], s82 offen nt lds
    s_add_u32 s82, s82, 131072
    s_waitcnt vmcnt(15)
    s_mov_b32 m0, s84
    s_add_u32 s84, s84, 4096
    buffer_load_dwordx4 v4, s[48:51], s82 offen nt lds
    s_add_u32 s82, s82, 131072
    s_waitcnt vmcnt(15)
    s_mov_b32 m0, s84
    s_add_u32 s84, s84, 4096
    buffer_load_dwordx4 v4, s[48:51], s82 offen nt lds
    s_add_u32 s82, s82, 131072
    s_waitcnt vmcnt(15)
    s_mov_b32 m0, s84
    s_add_u32 s84, s84, 4096
    buffer_load_dwordx4 v4, s[48:51], s82 offen nt lds
    s_add_u32 s82, s82, 131072
    s_waitcnt vmcnt(15)
    s_mov_b32 m0, s84
    s_add_u32 s84, s84, 4096
    buffer_load_dwordx4 v4, s[48:51], s82 offen nt lds
    s_add_u32 s82, s82, 131072
    s_waitcnt vmcnt(15)
    s_mov_b32 m0, s84
    s_add_u32 s84, s84, 4096
    buffer_load_dwordx4 v4, s[48:51], s82 offen nt lds
    s_add_u32 s82, s82, 131072
    s_waitcnt vmcnt(15)
    s_mov_b32 m0, s84
    s_add_u32 s84, s84, 4096
    buffer_load_dwordx4 v4, s[48:51], s82 offen nt lds
    s_add_u32 s82, s82, 131072
    s_waitcnt vmcnt(15)
    s_mov_b32 m0, s84
    s_add_u32 s84, s84, 4096
    buffer_load_dwordx4 v4, s[48:51], s82 offen nt lds
    s_waitcnt vmcnt(8) lgkmcnt(0)
    s_and_b32 s38, s73, 3
    s_add_u32 s39, s38, s78
    s_and_b32 s39, s39, 3
    s_mov_b32 s37, 16
    s_add_u32 s80, s80, 1
    s_mov_b32 s81, s80
    s_and_b32 s79, s80, 0xffff
    v_mov_b32 v7, s79
    s_mov_b32 s3, 0x00010001
    v_add_u32 v16, s80, v3
    v_add_u32 v19, 0, v16
    v_and_b32 v17, 1, v19
    v_bfe_u32 v18, v19, 1, 1
    v_lshl_or_b32 v244, v18, 16, v17
    v_add_u32 v19, 1, v16
    v_and_b32 v17, 1, v19
    v_bfe_u32 v18, v19, 1, 1
    v_lshl_or_b32 v245, v18, 16, v17
    v_add_u32 v19, 2, v16
    v_and_b32 v17, 1, v19
    v_bfe_u32 v18, v19, 1, 1
    v_lshl_or_b32 v246, v18, 16, v17
    v_add_u32 v19, 3, v16
    v_and_b32 v17, 1, v19
    v_bfe_u32 v18, v19, 1, 1
    v_lshl_or_b32 v247, v18, 16, v17
    s_barrier
    v_add_u32 v16, 98304, v8
    v_add_u32 v17, 98304, v9
    v_add_u32 v18, 98304, v10
    v_add_u32 v19, 98304, v11
    ds_read_b64_tr_b16 v[32:33], v16 offset:0
    ds_read_b64_tr_b16 v[34:35], v17 offset:0
    ds_read_b64_tr_b16 v[36:37], v16 offset:8192
    ds_read_b64_tr_b16 v[38:39], v17 offset:8192
    ds_read_b64_tr_b16 v[40:41], v16 offset:16384
    ds_read_b64_tr_b16 v[42:43], v17 offset:16384
    ds_read_b64_tr_b16 v[44:45], v16 offset:24576
    ds_read_b64_tr_b16 v[46:47], v17 offset:24576
    ds_read_b64_tr_b16 v[48:49], v18 offset:0
    ds_read_b64_tr_b16 v[50:51], v19 offset:0
    ds_read_b64_tr_b16 v[52:53], v18 offset:8192
    ds_read_b64_tr_b16 v[54:55], v19 offset:8192
    ds_read_b64_tr_b16 v[56:57], v18 offset:16384
    ds_read_b64_tr_b16 v[58:59], v19 offset:16384
    ds_read_b64_tr_b16 v[60:61], v18 offset:24576
    ds_read_b64_tr_b16 v[62:63], v19 offset:24576
    v_mov_b32 v80, 0
    v_mov_b32 v81, 0
    v_mov_b32 v82, 0
    v_mov_b32 v83, 0
    v_mov_b32 v84, 0
    v_mov_b32 v85, 0
    v_mov_b32 v86, 0
    v_mov_b32 v87, 0
    s_waitcnt lgkmcnt(0)
    s_nop 0
    v_mfma_f32_16x16x32_bf16 v[80:83], v[32:35], v[64:67], v[80:83]
    v_mfma_f32_16x16x32_bf16 v[84:87], v[48:51], v[64:67], v[84:87]
    v_mfma_f32_16x16x32_bf16 v[80:83], v[36:39], v[68:71], v[80:83]
    v_mfma_f32_16x16x32_bf16 v[84:87], v[52:55], v[68:71], v[84:87]
    v_mfma_f32_16x16x32_bf16 v[80:83], v[40:43], v[72:75], v[80:83]
    v_mfma_f32_16x16x32_bf16 v[84:87], v[56:59], v[72:75], v[84:87]
    v_mfma_f32_16x16x32_bf16 v[80:83], v[44:47], v[76:79], v[80:83]
    v_mfma_f32_16x16x32_bf16 v[84:87], v[60:63], v[76:79], v[84:87]
    s_nop 9
    s_lshl_b32 s96, s89, 13
    s_lshl_b32 s82, s77, 11
    s_add_u32 s82, s82, s96
    s_lshl_b32 s83, s78, 7
    s_add_u32 s97, s82, s83
    s_add_u32 s84, s97, 16777216
    v_mov_b32_dpp v80, v84 row_shr:4 row_mask:0xf bank_mask:0x2
    v_mov_b32_dpp v81, v85 row_shr:4 row_mask:0xf bank_mask:0x2
    v_mov_b32_dpp v82, v86 row_shr:4 row_mask:0xf bank_mask:0x2
    v_mov_b32_dpp v83, v87 row_shr:4 row_mask:0xf bank_mask:0x2
    v_cvt_pk_bf16_f32 v22, v80, v81
    v_lshl_or_b32 v252, v22, 16, v7
    v_and_or_b32 v253, v22, s101, v7
    v_cvt_pk_bf16_f32 v23, v82, v83
    v_lshl_or_b32 v254, v23, 16, v7
    v_and_or_b32 v255, v23, s101, v7
    s_mov_b32 s10, s84
    s_add_u32 s82, s84, 524288
    v_cmp_gt_u32 vcc, 8, v3
    s_and_saveexec_b64 s[90:91], vcc
    buffer_store_dwordx4 v[252:255], v13, s[64:67], s82 offen
    s_mov_b64 exec, s[90:91]
    s_barrier
    s_add_u32 s84, s96, 16777216
    v_lshlrev_b32 v21, 3, v1
    s_lshl_b32 s83, s78, 9
    s_add_u32 s83, s83, s84
    s_add_u32 s85, s83, 4096
    s_add_u32 s82, s83, 524288
    s_add_u32 s84, s85, 524288
    s_mov_b32 s6, 0
L_g4_1:
    s_add_u32 s100, s100, 1
    s_cmp_gt_u32 s100, 200000
    s_cbranch_scc1 L_end
    buffer_load_dwordx2 v[96:97], v21, s[64:67], s82 offen offset:0 sc1
    buffer_load_dwordx2 v[98:99], v21, s[64:67], s82 offen offset:2048 sc1
    buffer_load_dwordx2 v[100:101], v21, s[64:67], s84 offen offset:0 sc1
    buffer_load_dwordx2 v[102:103], v21, s[64:67], s84 offen offset:2048 sc1
    s_mov_b32 s93, 0
L_pw_3:
    s_getreg_b32 s92, hwreg(HW_REG_IB_STS)
    s_and_b32 s92, s92, 0x00c0000f
    s_cmp_le_u32 s92, s93
    s_cbranch_scc1 L_pd_4
    s_cmp_ge_u32 s93, 4
    s_cbranch_scc1 L_pw_3
    s_cmp_ge_u32 s88, s37
    s_cbranch_scc1 L_pw_3
    s_mov_b32 m0, s87
    s_and_b32 s98, s88, 7
    s_lshl_b32 s98, s98, 14
    s_lshr_b32 s99, s88, 3
    s_add_u32 s99, s99, s38
    s_and_b32 s99, s99, 3
    s_lshl_b32 s99, s99, 8
    s_add_u32 s98, s98, s99
    s_add_u32 s98, s98, s86
    buffer_load_dwordx4 v5, s[60:63], s98 offen nt lds
    s_add_u32 s87, s87, 4096
    s_add_u32 s88, s88, 1
    s_add_u32 s93, s93, 1
    s_branch L_pw_3
L_pd_4:
    v_xor_b32 v22, v96, v7
    v_xor_b32 v23, v97, v7
    v_or_b32 v22, v22, v23
    v_xor_b32 v23, v98, v7
    v_or_b32 v22, v22, v23
    v_xor_b32 v23, v99, v7
    v_or_b32 v22, v22, v23
    v_xor_b32 v23, v100, v7
    v_or_b32 v22, v22, v23
    v_xor_b32 v23, v101, v7
    v_or_b32 v22, v22, v23
    v_xor_b32 v23, v102, v7
    v_or_b32 v22, v22, v23
    v_xor_b32 v23, v103, v7
    v_or_b32 v22, v22, v23
    v_and_b32 v22, 0xffff, v22
    v_cmp_ne_u32 vcc, 0, v22
    s_cbranch_vccz L_g4ok_2
    s_add_u32 s6, s6, 1
    s_and_b32 s98, s6, 31
    s_cbranch_scc1 L_g4_1
    v_cmp_gt_u32 vcc, 8, v3
    s_and_saveexec_b64 s[90:91], vcc
    buffer_store_dwordx4 v[252:255], v13, s[64:67], s10 offen sc1
    s_mov_b64 exec, s[90:91]
    buffer_load_dwordx2 v[96:97], v21, s[64:67], s83 offen offset:0 sc1
    buffer_load_dwordx2 v[98:99], v21, s[64:67], s83 offen offset:2048 sc1
    buffer_load_dwordx2 v[100:101], v21, s[64:67], s85 offen offset:0 sc1
    buffer_load_dwordx2 v[102:103], v21, s[64:67], s85 offen offset:2048 sc1
    s_mov_b32 s93, 0
L_pw_5:
    s_getreg_b32 s92, hwreg(HW_REG_IB_STS)
    s_and_b32 s92, s92, 0x00c0000f
    s_cmp_le_u32 s92, s93
    s_cbranch_scc1 L_pd_6
    s_cmp_ge_u32 s93, 4
    s_cbranch_scc1 L_pw_5
    s_cmp_ge_u32 s88, s37
    s_cbranch_scc1 L_pw_5
    s_mov_b32 m0, s87
    s_and_b32 s98, s88, 7
    s_lshl_b32 s98, s98, 14
    s_lshr_b32 s99, s88, 3
    s_add_u32 s99, s99, s38
    s_and_b32 s99, s99, 3
    s_lshl_b32 s99, s99, 8
    s_add_u32 s98, s98, s99
    s_add_u32 s98, s98, s86
    buffer_load_dwordx4 v5, s[60:63], s98 offen nt lds
    s_add_u32 s87, s87, 4096
    s_add_u32 s88, s88, 1
    s_add_u32 s93, s93, 1
    s_branch L_pw_5
L_pd_6:
    v_xor_b32 v22, v96, v7
    v_xor_b32 v23, v97, v7
    v_or_b32 v22, v22, v23
    v_xor_b32 v23, v98, v7
    v_or_b32 v22, v22, v23
    v_xor_b32 v23, v99, v7
    v_or_b32 v22, v22, v23
    v_xor_b32 v23, v100, v7
    v_or_b32 v22, v22, v23
    v_xor_b32 v23, v101, v7
    v_or_b32 v22, v22, v23
    v_xor_b32 v23, v102, v7
    v_or_b32 v22, v22, v23
    v_xor_b32 v23, v103, v7
    v_or_b32 v22, v22, v23
    v_and_b32 v22, 0xffff, v22
    v_cmp_ne_u32 vcc, 0, v22
    s_cbranch_vccnz L_g4_1
L_g4ok_2:
    v_cmp_gt_u32 vcc, 8, v3
    s_and_saveexec_b64 s[90:91], vcc
    buffer_store_dwordx4 v[252:255], v13, s[64:67], s10 offen sc1
    s_mov_b64 exec, s[90:91]
    v_and_b32 v96, s101, v96
    v_and_b32 v98, s101, v98
    v_and_b32 v100, s101, v100
    v_and_b32 v102, s101, v102
    v_add_f32 v24, v96, v98
    v_add_f32 v26, v100, v102
    v_add_f32 v24, v24, v26
    v_and_b32 v97, s101, v97
    v_and_b32 v99, s101, v99
    v_and_b32 v101, s101, v101
    v_and_b32 v103, s101, v103
    v_add_f32 v25, v97, v99
    v_add_f32 v27, v101, v103
    v_add_f32 v25, v25, v27
    v_cvt_pk_bf16_f32 v24, v24, v25
    s_lshl_b32 s83, s78, 8
    s_add_u32 s83, s83, 131072
    v_lshl_add_u32 v21, v1, 2, s83
    ds_write_b32 v21, v24
    s_waitcnt lgkmcnt(0)
    s_barrier
    s_cmp_gt_u32 s88, 12
    s_cbranch_scc1 L_pg_7
    s_mov_b32 m0, s87
    s_and_b32 s98, s88, 7
    s_lshl_b32 s98, s98, 14
    s_lshr_b32 s99, s88, 3
    s_add_u32 s99, s99, s38
    s_and_b32 s99, s99, 3
    s_lshl_b32 s99, s99, 8
    s_add_u32 s98, s98, s99
    s_add_u32 s98, s98, s86
    buffer_load_dwordx4 v5, s[60:63], s98 offen nt lds
    s_add_u32 s87, s87, 4096
    s_add_u32 s88, s88, 1
    s_mov_b32 m0, s87
    s_and_b32 s98, s88, 7
    s_lshl_b32 s98, s98, 14
    s_lshr_b32 s99, s88, 3
    s_add_u32 s99, s99, s38
    s_and_b32 s99, s99, 3
    s_lshl_b32 s99, s99, 8
    s_add_u32 s98, s98, s99
    s_add_u32 s98, s98, s86
    buffer_load_dwordx4 v5, s[60:63], s98 offen nt lds
    s_add_u32 s87, s87, 4096
    s_add_u32 s88, s88, 1
    s_mov_b32 m0, s87
    s_and_b32 s98, s88, 7
    s_lshl_b32 s98, s98, 14
    s_lshr_b32 s99, s88, 3
    s_add_u32 s99, s99, s38
    s_and_b32 s99, s99, 3
    s_lshl_b32 s99, s99, 8
    s_add_u32 s98, s98, s99
    s_add_u32 s98, s98, s86
    buffer_load_dwordx4 v5, s[60:63], s98 offen nt lds
    s_add_u32 s87, s87, 4096
    s_add_u32 s88, s88, 1
    s_mov_b32 m0, s87
    s_and_b32 s98, s88, 7
    s_lshl_b32 s98, s98, 14
    s_lshr_b32 s99, s88, 3
    s_add_u32 s99, s99, s38
    s_and_b32 s99, s99, 3
    s_lshl_b32 s99, s99, 8
    s_add_u32 s98, s98, s99
    s_add_u32 s98, s98, s86
    buffer_load_dwordx4 v5, s[60:63], s98 offen nt lds
    s_add_u32 s87, s87, 4096
    s_add_u32 s88, s88, 1
L_pg_7:
    v_add_u32 v20, 131072, v12
    ds_read_b128 v[64:67], v20 offset:0
    ds_read_b128 v[68:71], v20 offset:64
    ds_read_b128 v[72:75], v20 offset:128
    ds_read_b128 v[76:79], v20 offset:192
    v_lshrrev_b32 v16, 2, v3
    v_xor_b32 v16, v16, v2
    v_and_b32 v17, 3, v3
    s_lshl_b32 s82, s78, 13
    s_add_u32 s82, s82, 65536
    v_lshl_add_u32 v18, v3, 8, s82
    v_lshl_add_u32 v18, v16, 4, v18
    v_xor_b32 v19, 0, v17
    v_lshl_add_u32 v24, v19, 6, v18
    v_xor_b32 v19, 1, v17
    v_lshl_add_u32 v25, v19, 6, v18
    v_xor_b32 v19, 2, v17
    v_lshl_add_u32 v26, v19, 6, v18
    v_xor_b32 v19, 3, v17
    v_lshl_add_u32 v27, v19, 6, v18
    ds_read_b128 v[32:35], v24 offset:0
    ds_read_b128 v[36:39], v25 offset:0
    ds_read_b128 v[40:43], v26 offset:0
    ds_read_b128 v[44:47], v27 offset:0
    ds_read_b128 v[48:51], v24 offset:4096
    ds_read_b128 v[52:55], v25 offset:4096
    ds_read_b128 v[56:59], v26 offset:4096
    ds_read_b128 v[60:63], v27 offset:4096
    v_mov_b32 v80, 0
    v_mov_b32 v81, 0
    v_mov_b32 v82, 0
    v_mov_b32 v83, 0
    v_mov_b32 v84, 0
    v_mov_b32 v85, 0
    v_mov_b32 v86, 0
    v_mov_b32 v87, 0
    s_waitcnt lgkmcnt(0)
    s_nop 0
    v_mfma_f32_16x16x32_bf16 v[80:83], v[32:35], v[64:67], v[80:83]
    v_mfma_f32_16x16x32_bf16 v[84:87], v[48:51], v[64:67], v[84:87]
    v_mfma_f32_16x16x32_bf16 v[80:83], v[36:39], v[68:71], v[80:83]
    v_mfma_f32_16x16x32_bf16 v[84:87], v[52:55], v[68:71], v[84:87]
    v_mfma_f32_16x16x32_bf16 v[80:83], v[40:43], v[72:75], v[80:83]
    v_mfma_f32_16x16x32_bf16 v[84:87], v[56:59], v[72:75], v[84:87]
    v_mfma_f32_16x16x32_bf16 v[80:83], v[44:47], v[76:79], v[80:83]
    v_mfma_f32_16x16x32_bf16 v[84:87], v[60:63], v[76:79], v[84:87]
    s_nop 9
    v_mov_b32_dpp v80, v84 row_shr:4 row_mask:0xf bank_mask:0x2
    v_mov_b32_dpp v81, v85 row_shr:4 row_mask:0xf bank_mask:0x2
    v_mov_b32_dpp v82, v86 row_shr:4 row_mask:0xf bank_mask:0x2
    v_mov_b32_dpp v83, v87 row_shr:4 row_mask:0xf bank_mask:0x2
    v_mul_f32 v80, s94, v80
    v_mul_f32 v81, s94, v81
    v_mul_f32 v82, s94, v82
    v_mul_f32 v83, s94, v83
    v_lshrrev_b32 v16, 2, v3
    v_lshrrev_b32 v17, 1, v2
    v_lshl_add_u32 v17, v16, 1, v17
    v_and_b32 v18, 1, v2
    v_lshl_add_u32 v17, v18, 1, v17
    v_add_u32 v17, s80, v17
    s_mov_b32 s82, 0xfffe0000
    v_add_u32 v18, 0, v17
    v_bfe_u32 v19, v18, 0, 1
    v_lshlrev_b32 v19, 16, v19
    v_add_u32 v80, 0x10000, v80
    v_and_or_b32 v80, v80, s82, v19
    v_bfe_u32 v19, v18, 1, 1
    v_lshlrev_b32 v19, 16, v19
    v_add_u32 v81, 0x10000, v81
    v_and_or_b32 v81, v81, s82, v19
    v_lshrrev_b32 v19, 16, v80
    v_or_b32 v24, v81, v19
    v_add_u32 v18, 1, v17
    v_bfe_u32 v19, v18, 0, 1
    v_lshlrev_b32 v19, 16, v19
    v_add_u32 v82, 0x10000, v82
    v_and_or_b32 v82, v82, s82, v19
    v_bfe_u32 v19, v18, 1, 1
    v_lshlrev_b32 v19, 16, v19
    v_add_u32 v83, 0x10000, v83
    v_and_or_b32 v83, v83, s82, v19
    v_lshrrev_b32 v19, 16, v82
    v_or_b32 v25, v83, v19
    v_and_b32 v20, 3, v3
    v_lshlrev_b32 v20, 15, v20
    v_lshl_add_u32 v20, v2, 3, v20
    v_lshl_add_u32 v20, v16, 5, v20
    s_lshl_b32 s82, s76, 17
    s_lshl_b32 s83, s7, 10
    s_add_u32 s82, s82, s83
    s_lshl_b32 s83, s77, 8
    s_add_u32 s82, s82, s83
    s_lshl_b32 s83, s78, 6
    s_add_u32 s82, s82, s83
    s_add_u32 s84, s82, 1048576
    v_cmp_gt_u32 vcc, 8, v3
    s_and_saveexec_b64 s[90:91], vcc
    buffer_store_dwordx2 v[24:25], v20, s[64:67], s84 offen sc1
    s_mov_b64 exec, s[90:91]
    s_barrier
    s_mov_b32 s37, 32
    v_and_b32 v16, 31, v1
    v_lshrrev_b32 v17, 5, v1
    v_and_b32 v18, 3, v16
    v_lshlrev_b32 v18, 2, v18
    v_bfe_u32 v19, v16, 2, 2
    v_or_b32 v18, v18, v19
    v_xor_b32 v18, v18, v17
    v_lshlrev_b32 v19, 8, v16
    s_lshl_b32 s82, s78, 13
    v_xor_b32 v20, 0, v18
    v_lshl_add_u32 v20, v20, 4, v19
    v_add_u32 v160, s82, v20
    v_add_u32 v168, 0x10000, v160
    v_add_u32 v176, 131072, v20
    v_xor_b32 v20, 2, v18
    v_lshl_add_u32 v20, v20, 4, v19
    v_add_u32 v161, s82, v20
    v_add_u32 v169, 0x10000, v161
    v_add_u32 v177, 131072, v20
    v_xor_b32 v20, 4, v18
    v_lshl_add_u32 v20, v20, 4, v19
    v_add_u32 v162, s82, v20
    v_add_u32 v170, 0x10000, v162
    v_add_u32 v178, 131072, v20
    v_xor_b32 v20, 6, v18
    v_lshl_add_u32 v20, v20, 4, v19
    v_add_u32 v163, s82, v20
    v_add_u32 v171, 0x10000, v163
    v_add_u32 v179, 131072, v20
    v_xor_b32 v20, 8, v18
    v_lshl_add_u32 v20, v20, 4, v19
    v_add_u32 v164, s82, v20
    v_add_u32 v172, 0x10000, v164
    v_add_u32 v180, 131072, v20
    v_xor_b32 v20, 10, v18
    v_lshl_add_u32 v20, v20, 4, v19
    v_add_u32 v165, s82, v20
    v_add_u32 v173, 0x10000, v165
    v_add_u32 v181, 131072, v20
    v_xor_b32 v20, 12, v18
    v_lshl_add_u32 v20, v20, 4, v19
    v_add_u32 v166, s82, v20
    v_add_u32 v174, 0x10000, v166
    v_add_u32 v182, 131072, v20
    v_xor_b32 v20, 14, v18
    v_lshl_add_u32 v20, v20, 4, v19
    v_add_u32 v167, s82, v20
    v_add_u32 v175, 0x10000, v167
    v_add_u32 v183, 131072, v20
    v_lshrrev_b32 v16, 2, v3
    v_and_b32 v18, 3, v3
    v_lshrrev_b32 v19, 1, v18
    v_and_b32 v18, 1, v18
    v_and_b32 v20, 1, v2
    v_lshl_add_u32 v19, v20, 1, v19
    v_lshl_add_u32 v20, v17, 2, v16
    s_lshl_b32 s82, s78, 15
    v_add_u32 v21, 0, v17
    v_xor_b32 v21, v21, v19
    v_xor_b32 v22, 0, v16
    v_lshl_add_u32 v21, v22, 2, v21
    v_lshlrev_b32 v21, 4, v21
    v_lshl_add_u32 v21, v18, 3, v21
    v_add_u32 v22, 0, v20
    v_lshl_add_u32 v21, v22, 8, v21
    v_add_u32 v184, s82, v21
    v_add_u32 v21, 2, v17
    v_xor_b32 v21, v21, v19
    v_xor_b32 v22, 0, v16
    v_lshl_add_u32 v21, v22, 2, v21
    v_lshlrev_b32 v21, 4, v21
    v_lshl_add_u32 v21, v18, 3, v21
    v_add_u32 v22, 8, v20
    v_lshl_add_u32 v21, v22, 8, v21
    v_add_u32 v185, s82, v21
    v_add_u32 v21, 0, v17
    v_xor_b32 v21, v21, v19
    v_xor_b32 v22, 1, v16
    v_lshl_add_u32 v21, v22, 2, v21
    v_lshlrev_b32 v21, 4, v21
    v_lshl_add_u32 v21, v18, 3, v21
    v_add_u32 v22, 0, v20
    v_lshl_add_u32 v21, v22, 8, v21
    v_add_u32 v186, s82, v21
    v_add_u32 v21, 2, v17
    v_xor_b32 v21, v21, v19
    v_xor_b32 v22, 1, v16
    v_lshl_add_u32 v21, v22, 2, v21
    v_lshlrev_b32 v21, 4, v21
    v_lshl_add_u32 v21, v18, 3, v21
    v_add_u32 v22, 8, v20
    v_lshl_add_u32 v21, v22, 8, v21
    v_add_u32 v187, s82, v21
    v_add_u32 v21, 0, v17
    v_xor_b32 v21, v21, v19
    v_xor_b32 v22, 2, v16
    v_lshl_add_u32 v21, v22, 2, v21
    v_lshlrev_b32 v21, 4, v21
    v_lshl_add_u32 v21, v18, 3, v21
    v_add_u32 v22, 0, v20
    v_lshl_add_u32 v21, v22, 8, v21
    v_add_u32 v188, s82, v21
    v_add_u32 v21, 2, v17
    v_xor_b32 v21, v21, v19
    v_xor_b32 v22, 2, v16
    v_lshl_add_u32 v21, v22, 2, v21
    v_lshlrev_b32 v21, 4, v21
    v_lshl_add_u32 v21, v18, 3, v21
    v_add_u32 v22, 8, v20
    v_lshl_add_u32 v21, v22, 8, v21
    v_add_u32 v189, s82, v21
    v_add_u32 v21, 0, v17
    v_xor_b32 v21, v21, v19
    v_xor_b32 v22, 3, v16
    v_lshl_add_u32 v21, v22, 2, v21
    v_lshlrev_b32 v21, 4, v21
    v_lshl_add_u32 v21, v18, 3, v21
    v_add_u32 v22, 0, v20
    v_lshl_add_u32 v21, v22, 8, v21
    v_add_u32 v190, s82, v21
    v_add_u32 v21, 2, v17
    v_xor_b32 v21, v21, v19
    v_xor_b32 v22, 3, v16
    v_lshl_add_u32 v21, v22, 2, v21
    v_lshlrev_b32 v21, 4, v21
    v_lshl_add_u32 v21, v18, 3, v21
    v_add_u32 v22, 8, v20
    v_lshl_add_u32 v21, v22, 8, v21
    v_add_u32 v191, s82, v21
    s_lshl_b32 s83, s72, 15
    s_lshl_b32 s82, s78, 13
    s_add_u32 s83, s83, s82
    s_add_u32 s83, s83, 1048576
    s_add_u32 s84, s83, 4096
    v_subrev_u32 v16, s38, v2
    v_and_b32 v16, 3, v16
    v_lshlrev_b32 v16, 13, v16
    v_lshl_add_u32 v16, v3, 4, v16
    s_lshl_b32 s82, s78, 1
    s_and_b32 s82, s82, 3
    s_lshl_b32 s82, s82, 4
    v_xor_b32 v17, s82, v16
    v_xor_b32 v18, 16, v17
    s_lshl_b32 s82, s78, 11
    s_add_u32 s82, s82, 131072
    v_xor_b32 v128, 0, v17
    v_add_u32 v128, s82, v128
    v_xor_b32 v129, 64, v17
    v_add_u32 v129, s82, v129
    v_xor_b32 v130, 128, v17
    v_add_u32 v130, s82, v130
    v_xor_b32 v131, 192, v17
    v_add_u32 v131, s82, v131
    v_xor_b32 v132, 0, v18
    v_add_u32 v132, s82, v132
    v_xor_b32 v133, 64, v18
    v_add_u32 v133, s82, v133
    v_xor_b32 v134, 128, v18
    v_add_u32 v134, s82, v134
    v_xor_b32 v135, 192, v18
    v_add_u32 v135, s82, v135
    v_mov_b32 v192, 0
    v_mov_b32 v193, 0
    v_mov_b32 v194, 0
    v_mov_b32 v195, 0
    v_mov_b32 v196, 0
    v_mov_b32 v197, 0
    v_mov_b32 v198, 0
    v_mov_b32 v199, 0
    v_mov_b32 v200, 0
    v_mov_b32 v201, 0
    v_mov_b32 v202, 0
    v_mov_b32 v203, 0
    v_mov_b32 v204, 0
    v_mov_b32 v205, 0
    v_mov_b32 v206, 0
    v_mov_b32 v207, 0
    v_accvgpr_write_b32 a0, 0
    v_accvgpr_write_b32 a1, 0
    v_accvgpr_write_b32 a2, 0
    v_accvgpr_write_b32 a3, 0
    v_accvgpr_write_b32 a4, 0
    v_accvgpr_write_b32 a5, 0
    v_accvgpr_write_b32 a6, 0
    v_accvgpr_write_b32 a7, 0
    v_accvgpr_write_b32 a8, 0
    v_accvgpr_write_b32 a9, 0
    v_accvgpr_write_b32 a10, 0
    v_accvgpr_write_b32 a11, 0
    v_accvgpr_write_b32 a12, 0
    v_accvgpr_write_b32 a13, 0
    v_accvgpr_write_b32 a14, 0
    v_accvgpr_write_b32 a15, 0
    v_accvgpr_write_b32 a16, 0
    v_accvgpr_write_b32 a17, 0
    v_accvgpr_write_b32 a18, 0
    v_accvgpr_write_b32 a19, 0
    v_accvgpr_write_b32 a20, 0
    v_accvgpr_write_b32 a21, 0
    v_accvgpr_write_b32 a22, 0
    v_accvgpr_write_b32 a23, 0
    v_accvgpr_write_b32 a24, 0
    v_accvgpr_write_b32 a25, 0
    v_accvgpr_write_b32 a26, 0
    v_accvgpr_write_b32 a27, 0
    v_accvgpr_write_b32 a28, 0
    v_accvgpr_write_b32 a29, 0
    v_accvgpr_write_b32 a30, 0
    v_accvgpr_write_b32 a31, 0
    v_accvgpr_write_b32 a32, 0
    v_accvgpr_write_b32 a33, 0
    v_accvgpr_write_b32 a34, 0
    v_accvgpr_write_b32 a35, 0
    v_accvgpr_write_b32 a36, 0
    v_accvgpr_write_b32 a37, 0
    v_accvgpr_write_b32 a38, 0
    v_accvgpr_write_b32 a39, 0
    v_accvgpr_write_b32 a40, 0
    v_accvgpr_write_b32 a41, 0
    v_accvgpr_write_b32 a42, 0
    v_accvgpr_write_b32 a43, 0
    v_accvgpr_write_b32 a44, 0
    v_accvgpr_write_b32 a45, 0
    v_accvgpr_write_b32 a46, 0
    v_accvgpr_write_b32 a47, 0
    v_accvgpr_write_b32 a48, 0
    v_accvgpr_write_b32 a49, 0
    v_accvgpr_write_b32 a50, 0
    v_accvgpr_write_b32 a51, 0
    v_accvgpr_write_b32 a52, 0
    v_accvgpr_write_b32 a53, 0
    v_accvgpr_write_b32 a54, 0
    v_accvgpr_write_b32 a55, 0
    v_accvgpr_write_b32 a56, 0
    v_accvgpr_write_b32 a57, 0
    v_accvgpr_write_b32 a58, 0
    v_accvgpr_write_b32 a59, 0
    v_accvgpr_write_b32 a60, 0
    v_accvgpr_write_b32 a61, 0
    v_accvgpr_write_b32 a62, 0
    v_accvgpr_write_b32 a63, 0
L_pre_8:
    s_cmp_ge_u32 s88, 22
    s_cbranch_scc1 L_pred_9
    s_waitcnt vmcnt(7)
    s_mov_b32 m0, s87
    s_and_b32 s98, s88, 7
    s_lshl_b32 s98, s98, 14
    s_lshr_b32 s99, s88, 3
    s_add_u32 s99, s99, s38
    s_and_b32 s99, s99, 3
    s_lshl_b32 s99, s99, 8
    s_add_u32 s98, s98, s99
    s_add_u32 s98, s98, s86
    buffer_load_dwordx4 v5, s[60:63], s98 offen nt lds
    s_add_u32 s87, s87, 4096
    s_add_u32 s88, s88, 1
    s_branch L_pre_8
L_pred_9:
L_h1_10:
    s_add_u32 s100, s100, 1
    s_cmp_gt_u32 s100, 200000
    s_cbranch_scc1 L_end
    buffer_load_dwordx4 v[96:99], v6, s[64:67], s83 offen offset:0 sc1
    buffer_load_dwordx4 v[100:103], v6, s[64:67], s83 offen offset:1024 sc1
    buffer_load_dwordx4 v[104:107], v6, s[64:67], s83 offen offset:2048 sc1
    buffer_load_dwordx4 v[108:111], v6, s[64:67], s83 offen offset:3072 sc1
    buffer_load_dwordx4 v[112:115], v6, s[64:67], s84 offen offset:0 sc1
    buffer_load_dwordx4 v[116:119], v6, s[64:67], s84 offen offset:1024 sc1
    buffer_load_dwordx4 v[120:123], v6, s[64:67], s84 offen offset:2048 sc1
    buffer_load_dwordx4 v[124:127], v6, s[64:67], s84 offen offset:3072 sc1
    s_mov_b32 s93, 0
L_pw_11:
    s_getreg_b32 s92, hwreg(HW_REG_IB_STS)
    s_and_b32 s92, s92, 0x00c0000f
    s_cmp_le_u32 s92, s93
    s_cbranch_scc1 L_pd_12
    s_cmp_ge_u32 s93, 8
    s_cbranch_scc1 L_pw_11
    s_cmp_ge_u32 s88, s37
    s_cbranch_scc1 L_pw_11
    s_mov_b32 m0, s87
    s_and_b32 s98, s88, 7
    s_lshl_b32 s98, s98, 14
    s_lshr_b32 s99, s88, 3
    s_add_u32 s99, s99, s38
    s_and_b32 s99, s99, 3
    s_lshl_b32 s99, s99, 8
    s_add_u32 s98, s98, s99
    s_add_u32 s98, s98, s86
    buffer_load_dwordx4 v5, s[60:63], s98 offen nt lds
    s_add_u32 s87, s87, 4096
    s_add_u32 s88, s88, 1
    s_add_u32 s93, s93, 1
    s_branch L_pw_11
L_pd_12:
    v_xor_b32 v22, v96, v244
    v_xor_b32 v23, v97, v245
    v_or_b32 v22, v22, v23
    v_xor_b32 v23, v98, v246
    v_or_b32 v22, v22, v23
    v_xor_b32 v23, v99, v247
    v_or_b32 v22, v22, v23
    v_xor_b32 v23, v100, v244
    v_or_b32 v22, v22, v23
    v_xor_b32 v23, v101, v245
    v_or_b32 v22, v22, v23
    v_xor_b32 v23, v102, v246
    v_or_b32 v22, v22, v23
    v_xor_b32 v23, v103, v247
    v_or_b32 v22, v22, v23
    v_xor_b32 v23, v104, v244
    v_or_b32 v22, v22, v23
    v_xor_b32 v23, v105, v245
    v_or_b32 v22, v22, v23
    v_xor_b32 v23, v106, v246
    v_or_b32 v22, v22, v23
    v_xor_b32 v23, v107, v247
    v_or_b32 v22, v22, v23
    v_xor_b32 v23, v108, v244
    v_or_b32 v22, v22, v23
    v_xor_b32 v23, v109, v245
    v_or_b32 v22, v22, v23
    v_xor_b32 v23, v110, v246
    v_or_b32 v22, v22, v23
    v_xor_b32 v23, v111, v247
    v_or_b32 v22, v22, v23
    v_xor_b32 v23, v112, v244
    v_or_b32 v22, v22, v23
    v_xor_b32 v23, v113, v245
    v_or_b32 v22, v22, v23
    v_xor_b32 v23, v114, v246
    v_or_b32 v22, v22, v23
    v_xor_b32 v23, v115, v247
    v_or_b32 v22, v22, v23
    v_xor_b32 v23, v116, v244
    v_or_b32 v22, v22, v23
    v_xor_b32 v23, v117, v245
    v_or_b32 v22, v22, v23
    v_xor_b32 v23, v118, v246
    v_or_b32 v22, v22, v23
    v_xor_b32 v23, v119, v247
    v_or_b32 v22, v22, v23
    v_xor_b32 v23, v120, v244
    v_or_b32 v22, v22, v23
    v_xor_b32 v23, v121, v245
    v_or_b32 v22, v22, v23
    v_xor_b32 v23, v122, v246
    v_or_b32 v22, v22, v23
    v_xor_b32 v23, v123, v247
    v_or_b32 v22, v22, v23
    v_xor_b32 v23, v124, v244
    v_or_b32 v22, v22, v23
    v_xor_b32 v23, v125, v245
    v_or_b32 v22, v22, v23
    v_xor_b32 v23, v126, v246
    v_or_b32 v22, v22, v23
    v_xor_b32 v23, v127, v247
    v_or_b32 v22, v22, v23
    v_and_b32 v22, s3, v22
    v_cmp_ne_u32 vcc, 0, v22
    s_cbranch_vccnz L_h1_10
    v_bfi_b32 v96, s3, 0, v96
    v_bfi_b32 v97, s3, 0, v97
    v_bfi_b32 v98, s3, 0, v98
    v_bfi_b32 v99, s3, 0, v99
    ds_write_b128 v128, v[96:99] offset:0
    v_bfi_b32 v100, s3, 0, v100
    v_bfi_b32 v101, s3, 0, v101
    v_bfi_b32 v102, s3, 0, v102
    v_bfi_b32 v103, s3, 0, v103
    ds_write_b128 v129, v[100:103] offset:256
    v_bfi_b32 v104, s3, 0, v104
    v_bfi_b32 v105, s3, 0, v105
    v_bfi_b32 v106, s3, 0, v106
    v_bfi_b32 v107, s3, 0, v107
    ds_write_b128 v130, v[104:107] offset:512
    v_bfi_b32 v108, s3, 0, v108
    v_bfi_b32 v109, s3, 0, v109
    v_bfi_b32 v110, s3, 0, v110
    v_bfi_b32 v111, s3, 0, v111
    ds_write_b128 v131, v[108:111] offset:768
    v_bfi_b32 v112, s3, 0, v112
    v_bfi_b32 v113, s3, 0, v113
    v_bfi_b32 v114, s3, 0, v114
    v_bfi_b32 v115, s3, 0, v115
    ds_write_b128 v132, v[112:115] offset:1024
    v_bfi_b32 v116, s3, 0, v116
    v_bfi_b32 v117, s3, 0, v117
    v_bfi_b32 v118, s3, 0, v118
    v_bfi_b32 v119, s3, 0, v119
    ds_write_b128 v133, v[116:119] offset:1280
    v_bfi_b32 v120, s3, 0, v120
    v_bfi_b32 v121, s3, 0, v121
    v_bfi_b32 v122, s3, 0, v122
    v_bfi_b32 v123, s3, 0, v123
    ds_write_b128 v134, v[120:123] offset:1536
    v_bfi_b32 v124, s3, 0, v124
    v_bfi_b32 v125, s3, 0, v125
    v_bfi_b32 v126, s3, 0, v126
    v_bfi_b32 v127, s3, 0, v127
    ds_write_b128 v135, v[124:127] offset:1792
L_rest_13:
    s_cmp_ge_u32 s88, 32
    s_cbranch_scc1 L_restd_14
    s_mov_b32 m0, s87
    s_and_b32 s98, s88, 7
    s_lshl_b32 s98, s98, 14
    s_lshr_b32 s99, s88, 3
    s_add_u32 s99, s99, s38
    s_and_b32 s99, s99, 3
    s_lshl_b32 s99, s99, 8
    s_add_u32 s98, s98, s99
    s_add_u32 s98, s98, s86
    buffer_load_dwordx4 v5, s[60:63], s98 offen nt lds
    s_add_u32 s87, s87, 4096
    s_add_u32 s88, s88, 1
    s_branch L_rest_13
L_restd_14:
    s_lshl_b32 s83, s78, 15
    s_add_u32 s82, s95, s83
    s_lshl_b32 s85, s7, 17
    s_lshl_b32 s83, s77, 8
    s_add_u32 s85, s85, s83
    s_lshl_b32 s83, s78, 12
    s_add_u32 s85, s85, s83
    s_waitcnt vmcnt(8) lgkmcnt(0)
    s_barrier
    ds_read_b128 v[32:35], v160 offset:0
    ds_read_b128 v[36:39], v176 offset:0
    ds_read_b128 v[40:43], v161 offset:0
    ds_read_b128 v[44:47], v177 offset:0
    ds_read_b128 v[48:51], v162 offset:0
    ds_read_b128 v[52:55], v178 offset:0
    ds_read_b128 v[56:59], v163 offset:0
    ds_read_b128 v[60:63], v179 offset:0
    s_waitcnt lgkmcnt(6)
    v_mfma_f32_32x32x16_bf16 v[192:207], v[32:35], v[36:39], v[192:207]
    buffer_load_dwordx4 a[64:67], v4, s[52:55], s82 offen nt
    s_add_u32 s82, s82, 131072
    ds_read_b128 v[32:35], v164 offset:0
    ds_read_b128 v[36:39], v180 offset:0
    s_waitcnt lgkmcnt(6)
    v_mfma_f32_32x32x16_bf16 v[192:207], v[40:43], v[44:47], v[192:207]
    ds_read_b128 v[40:43], v165 offset:0
    ds_read_b128 v[44:47], v181 offset:0
    s_waitcnt lgkmcnt(6)
    v_mfma_f32_32x32x16_bf16 v[192:207], v[48:51], v[52:55], v[192:207]
    ds_read_b128 v[48:51], v166 offset:0
    ds_read_b128 v[52:55], v182 offset:0
    s_waitcnt lgkmcnt(6)
    v_mfma_f32_32x32x16_bf16 v[192:207], v[56:59], v[60:63], v[192:207]
    buffer_load_dwordx4 a[68:71], v4, s[52:55], s82 offen nt
    s_add_u32 s82, s82, 131072
    ds_read_b128 v[56:59], v167 offset:0
    ds_read_b128 v[60:63], v183 offset:0
    s_waitcnt lgkmcnt(6)
    v_mfma_f32_32x32x16_bf16 v[192:207], v[32:35], v[36:39], v[192:207]
    ds_read_b128 v[32:35], v160 offset:32768
    ds_read_b128 v[36:39], v176 offset:8192
    s_waitcnt lgkmcnt(6)
    v_mfma_f32_32x32x16_bf16 v[192:207], v[40:43], v[44:47], v[192:207]
    ds_read_b128 v[40:43], v161 offset:32768
    ds_read_b128 v[44:47], v177 offset:8192
    s_waitcnt lgkmcnt(6)
    v_mfma_f32_32x32x16_bf16 v[192:207], v[48:51], v[52:55], v[192:207]
    buffer_load_dwordx4 a[72:75], v4, s[52:55], s82 offen nt
    s_add_u32 s82, s82, 131072
    ds_read_b128 v[48:51], v162 offset:32768
    ds_read_b128 v[52:55], v178 offset:8192
    s_waitcnt lgkmcnt(6)
    v_mfma_f32_32x32x16_bf16 v[192:207], v[56:59], v[60:63], v[192:207]
    ds_read_b128 v[56:59], v163 offset:32768
    ds_read_b128 v[60:63], v179 offset:8192
    s_waitcnt lgkmcnt(6)
    v_mfma_f32_32x32x16_bf16 v[192:207], v[32:35], v[36:39], v[192:207]
    ds_read_b128 v[32:35], v164 offset:32768
    ds_read_b128 v[36:39], v180 offset:8192
    s_waitcnt lgkmcnt(6)
    v_mfma_f32_32x32x16_bf16 v[192:207], v[40:43], v[44:47], v[192:207]
    buffer_load_dwordx4 a[76:79], v4, s[52:55], s82 offen nt
    s_add_u32 s82, s82, 131072
    ds_read_b128 v[40:43], v165 offset:32768
    ds_read_b128 v[44:47], v181 offset:8192
    s_waitcnt lgkmcnt(6)
    v_mfma_f32_32x32x16_bf16 v[192:207], v[48:51], v[52:55], v[192:207]
    ds_read_b128 v[48:51], v166 offset:32768
    ds_read_b128 v[52:55], v182 offset:8192
    s_waitcnt lgkmcnt(6)
    v_mfma_f32_32x32x16_bf16 v[192:207], v[56:59], v[60:63], v[192:207]
    ds_read_b128 v[56:59], v167 offset:32768
    ds_read_b128 v[60:63], v183 offset:8192
    s_waitcnt lgkmcnt(6)
    v_mfma_f32_32x32x16_bf16 v[192:207], v[32:35], v[36:39], v[192:207]
    buffer_load_dwordx4 a[80:83], v4, s[52:55], s82 offen nt
    s_add_u32 s82, s82, 131072
    ds_read_b128 v[32:35], v168 offset:0
    ds_read_b128 v[36:39], v176 offset:16384
    s_waitcnt lgkmcnt(6)
    v_mfma_f32_32x32x16_bf16 v[192:207], v[40:43], v[44:47], v[192:207]
    ds_read_b128 v[40:43], v169 offset:0
    ds_read_b128 v[44:47], v177 offset:16384
    s_waitcnt lgkmcnt(6)
    v_mfma_f32_32x32x16_bf16 v[192:207], v[48:51], v[52:55], v[192:207]
    ds_read_b128 v[48:51], v170 offset:0
    ds_read_b128 v[52:55], v178 offset:16384
    s_waitcnt lgkmcnt(6)
    v_mfma_f32_32x32x16_bf16 v[192:207], v[56:59], v[60:63], v[192:207]
    buffer_load_dwordx4 a[84:87], v4, s[52:55], s82 offen nt
    s_add_u32 s82, s82, 131072
    ds_read_b128 v[56:59], v171 offset:0
    ds_read_b128 v[60:63], v179 offset:16384
    s_waitcnt lgkmcnt(6)
    v_mfma_f32_32x32x16_bf16 v[192:207], v[32:35], v[36:39], v[192:207]
    ds_read_b128 v[32:35], v172 offset:0
    ds_read_b128 v[36:39], v180 offset:16384
    s_waitcnt lgkmcnt(6)
    v_mfma_f32_32x32x16_bf16 v[192:207], v[40:43], v[44:47], v[192:207]
    ds_read_b128 v[40:43], v173 offset:0
    ds_read_b128 v[44:47], v181 offset:16384
    s_waitcnt lgkmcnt(6)
    v_mfma_f32_32x32x16_bf16 v[192:207], v[48:51], v[52:55], v[192:207]
    buffer_load_dwordx4 a[88:91], v4, s[52:55], s82 offen nt
    s_add_u32 s82, s82, 131072
    ds_read_b128 v[48:51], v174 offset:0
    ds_read_b128 v[52:55], v182 offset:16384
    s_waitcnt lgkmcnt(6)
    v_mfma_f32_32x32x16_bf16 v[192:207], v[56:59], v[60:63], v[192:207]
    ds_read_b128 v[56:59], v175 offset:0
    ds_read_b128 v[60:63], v183 offset:16384
    s_waitcnt lgkmcnt(6)
    v_mfma_f32_32x32x16_bf16 v[192:207], v[32:35], v[36:39], v[192:207]
    s_waitcnt lgkmcnt(4)
    v_mfma_f32_32x32x16_bf16 v[192:207], v[40:43], v[44:47], v[192:207]
    buffer_load_dwordx4 a[92:95], v4, s[52:55], s82 offen nt
    s_waitcnt lgkmcnt(2)
    v_mfma_f32_32x32x16_bf16 v[192:207], v[48:51], v[52:55], v[192:207]
    s_waitcnt lgkmcnt(0)
    v_mfma_f32_32x32x16_bf16 v[192:207], v[56:59], v[60:63], v[192:207]
    s_waitcnt vmcnt(8)
    s_barrier
    ds_read_b128 v[32:35], v168 offset:32768
    ds_read_b128 v[36:39], v176 offset:24576
    ds_read_b128 v[40:43], v169 offset:32768
    ds_read_b128 v[44:47], v177 offset:24576
    ds_read_b128 v[48:51], v170 offset:32768
    ds_read_b128 v[52:55], v178 offset:24576
    ds_read_b128 v[56:59], v171 offset:32768
    ds_read_b128 v[60:63], v179 offset:24576
    s_waitcnt lgkmcnt(6)
    v_mfma_f32_32x32x16_bf16 v[192:207], v[32:35], v[36:39], v[192:207]
    ds_read_b128 v[32:35], v172 offset:32768
    ds_read_b128 v[36:39], v180 offset:24576
    s_waitcnt lgkmcnt(6)
    v_mfma_f32_32x32x16_bf16 v[192:207], v[40:43], v[44:47], v[192:207]
    ds_read_b128 v[40:43], v173 offset:32768
    ds_read_b128 v[44:47], v181 offset:24576
    s_waitcnt lgkmcnt(6)
    v_mfma_f32_32x32x16_bf16 v[192:207], v[48:51], v[52:55], v[192:207]
    ds_read_b128 v[48:51], v174 offset:32768
    ds_read_b128 v[52:55], v182 offset:24576
    s_waitcnt lgkmcnt(6)
    v_mfma_f32_32x32x16_bf16 v[192:207], v[56:59], v[60:63], v[192:207]
    ds_read_b128 v[56:59], v175 offset:32768
    ds_read_b128 v[60:63], v183 offset:24576
    s_waitcnt lgkmcnt(6)
    v_mfma_f32_32x32x16_bf16 v[192:207], v[32:35], v[36:39], v[192:207]
    s_waitcnt lgkmcnt(4)
    v_mfma_f32_32x32x16_bf16 v[192:207], v[40:43], v[44:47], v[192:207]
    s_waitcnt lgkmcnt(2)
    v_mfma_f32_32x32x16_bf16 v[192:207], v[48:51], v[52:55], v[192:207]
    s_waitcnt lgkmcnt(0)
    v_mfma_f32_32x32x16_bf16 v[192:207], v[56:59], v[60:63], v[192:207]
    s_nop 13
    v_max3_f32 v16, v192, v193, v194
    v_max3_f32 v16, v16, v195, v196
    v_max3_f32 v16, v16, v197, v198
    v_max3_f32 v16, v16, v199, v200
    v_max3_f32 v16, v16, v201, v202
    v_max3_f32 v16, v16, v203, v204
    v_max3_f32 v16, v16, v205, v206
    v_max_f32 v16, v16, v207
    v_mov_b32 v17, v16
    s_nop 1
    v_permlane32_swap_b32 v16, v17
    s_nop 0
    v_max_f32 v16, v16, v17
    v_and_b32 v18, 31, v1
    v_lshlrev_b32 v18, 2, v18
    s_lshl_b32 s82, s78, 7
    v_add_u32 v19, s82, v18
    v_add_u32 v19, 139264, v19
    ds_write_b32 v19, v16
    s_waitcnt lgkmcnt(0)
    s_barrier
    v_add_u32 v20, 139264, v18
    ds_read_b32 v24, v20 offset:0
    ds_read_b32 v25, v20 offset:128
    ds_read_b32 v26, v20 offset:256
    ds_read_b32 v27, v20 offset:384
    s_waitcnt lgkmcnt(0)
    v_max3_f32 v240, v24, v25, v26
    v_max_f32 v240, v240, v27
    v_sub_f32 v192, v192, v240
    v_sub_f32 v193, v193, v240
    v_sub_f32 v194, v194, v240
    v_sub_f32 v195, v195, v240
    v_sub_f32 v196, v196, v240
    v_sub_f32 v197, v197, v240
    v_sub_f32 v198, v198, v240
    v_sub_f32 v199, v199, v240
    v_sub_f32 v200, v200, v240
    v_sub_f32 v201, v201, v240
    v_sub_f32 v202, v202, v240
    v_sub_f32 v203, v203, v240
    v_sub_f32 v204, v204, v240
    v_sub_f32 v205, v205, v240
    v_sub_f32 v206, v206, v240
    v_sub_f32 v207, v207, v240
    v_exp_f32 v192, v192
    v_exp_f32 v193, v193
    v_exp_f32 v194, v194
    v_exp_f32 v195, v195
    v_exp_f32 v196, v196
    v_exp_f32 v197, v197
    v_exp_f32 v198, v198
    v_exp_f32 v199, v199
    v_exp_f32 v200, v200
    v_exp_f32 v201, v201
    v_exp_f32 v202, v202
    v_exp_f32 v203, v203
    v_exp_f32 v204, v204
    v_exp_f32 v205, v205
    v_exp_f32 v206, v206
    v_exp_f32 v207, v207
    s_nop 0
    v_add_f32 v241, v192, v193
    v_add_f32 v241, v241, v194
    v_add_f32 v241, v241, v195
    v_add_f32 v241, v241, v196
    v_add_f32 v241, v241, v197
    v_add_f32 v241, v241, v198
    v_add_f32 v241, v241, v199
    v_add_f32 v241, v241, v200
    v_add_f32 v241, v241, v201
    v_add_f32 v241, v241, v202
    v_add_f32 v241, v241, v203
    v_add_f32 v241, v241, v204
    v_add_f32 v241, v241, v205
    v_add_f32 v241, v241, v206
    v_add_f32 v241, v241, v207
    v_cvt_pk_bf16_f32 v24, v192, v193
    v_cvt_pk_bf16_f32 v25, v194, v195
    v_cvt_pk_bf16_f32 v26, v196, v197
    v_cvt_pk_bf16_f32 v27, v198, v199
    v_cvt_pk_bf16_f32 v28, v200, v201
    v_cvt_pk_bf16_f32 v29, v202, v203
    v_cvt_pk_bf16_f32 v30, v204, v205
    v_cvt_pk_bf16_f32 v31, v206, v207
    v_mov_b32 v17, v241
    s_nop 1
    v_permlane32_swap_b32 v241, v17
    s_nop 0
    v_add_f32 v241, v241, v17
    ds_write_b32 v19, v241 offset:512
    s_lshl_b32 s82, s78, 11
    s_add_u32 s82, s82, 131072
    v_add_u32 v21, s82, v6
    ds_write_b128 v21, v[24:27]
    ds_write_b128 v21, v[28:31] offset:1024
    s_waitcnt lgkmcnt(0)
    s_barrier
    v_add_u32 v21, 131072, v6
    ds_read_b128 v[208:211], v21 offset:0
    ds_read_b128 v[212:215], v21 offset:1024
    ds_read_b128 v[216:219], v21 offset:2048
    ds_read_b128 v[220:223], v21 offset:3072
    ds_read_b128 v[224:227], v21 offset:4096
    ds_read_b128 v[228:231], v21 offset:5120
    ds_read_b128 v[232:235], v21 offset:6144
    ds_read_b128 v[236:239], v21 offset:7168
    ds_read_b32 v24, v20 offset:512
    ds_read_b32 v25, v20 offset:640
    ds_read_b32 v26, v20 offset:768
    ds_read_b32 v27, v20 offset:896
    ds_read_b64_tr_b16 v[32:33], v184 offset:0
    ds_read_b64_tr_b16 v[34:35], v185 offset:0
    ds_read_b64_tr_b16 v[36:37], v186 offset:0
    ds_read_b64_tr_b16 v[38:39], v187 offset:0
    ds_read_b64_tr_b16 v[40:41], v188 offset:0
    ds_read_b64_tr_b16 v[42:43], v189 offset:0
    ds_read_b64_tr_b16 v[44:45], v190 offset:0
    ds_read_b64_tr_b16 v[46:47], v191 offset:0
    ds_read_b64_tr_b16 v[48:49], v184 offset:4096
    ds_read_b64_tr_b16 v[50:51], v185 offset:4096
    ds_read_b64_tr_b16 v[52:53], v186 offset:4096
    ds_read_b64_tr_b16 v[54:55], v187 offset:4096
    s_waitcnt lgkmcnt(10)
    v_mfma_f32_32x32x16_bf16 a[0:15], v[32:35], v[208:211], a[0:15]
    buffer_load_dwordx4 a[96:99], v5, s[56:59], s85 offen nt
    s_add_u32 s85, s85, 16384
    ds_read_b64_tr_b16 v[32:33], v188 offset:4096
    ds_read_b64_tr_b16 v[34:35], v189 offset:4096
    s_waitcnt lgkmcnt(10)
    v_mfma_f32_32x32x16_bf16 a[16:31], v[36:39], v[208:211], a[16:31]
    ds_read_b64_tr_b16 v[36:37], v190 offset:4096
    ds_read_b64_tr_b16 v[38:39], v191 offset:4096
    s_waitcnt lgkmcnt(10)
    v_mfma_f32_32x32x16_bf16 a[32:47], v[40:43], v[208:211], a[32:47]
    ds_read_b64_tr_b16 v[40:41], v184 offset:8192
    ds_read_b64_tr_b16 v[42:43], v185 offset:8192
    s_waitcnt lgkmcnt(10)
    v_mfma_f32_32x32x16_bf16 a[48:63], v[44:47], v[208:211], a[48:63]
    ds_read_b64_tr_b16 v[44:45], v186 offset:8192
    ds_read_b64_tr_b16 v[46:47], v187 offset:8192
    s_waitcnt lgkmcnt(10)
    v_mfma_f32_32x32x16_bf16 a[0:15], v[48:51], v[212:215], a[0:15]
    buffer_load_dwordx4 a[100:103], v5, s[56:59], s85 offen nt
    s_add_u32 s85, s85, 16384
    ds_read_b64_tr_b16 v[48:49], v188 offset:8192
    ds_read_b64_tr_b16 v[50:51], v189 offset:8192
    s_waitcnt lgkmcnt(10)
    v_mfma_f32_32x32x16_bf16 a[16:31], v[52:55], v[212:215], a[16:31]
    ds_read_b64_tr_b16 v[52:53], v190 offset:8192
    ds_read_b64_tr_b16 v[54:55], v191 offset:8192
    s_waitcnt lgkmcnt(10)
    v_mfma_f32_32x32x16_bf16 a[32:47], v[32:35], v[212:215], a[32:47]
    ds_read_b64_tr_b16 v[32:33], v184 offset:12288
    ds_read_b64_tr_b16 v[34:35], v185 offset:12288
    s_waitcnt lgkmcnt(10)
    v_mfma_f32_32x32x16_bf16 a[48:63], v[36:39], v[212:215], a[48:63]
    ds_read_b64_tr_b16 v[36:37], v186 offset:12288
    ds_read_b64_tr_b16 v[38:39], v187 offset:12288
    s_waitcnt lgkmcnt(10)
    v_mfma_f32_32x32x16_bf16 a[0:15], v[40:43], v[216:219], a[0:15]
    buffer_load_dwordx4 a[104:107], v5, s[56:59], s85 offen nt
    s_add_u32 s85, s85, 16384
    ds_read_b64_tr_b16 v[40:41], v188 offset:12288
    ds_read_b64_tr_b16 v[42:43], v189 offset:12288
    s_waitcnt lgkmcnt(10)
    v_mfma_f32_32x32x16_bf16 a[16:31], v[44:47], v[216:219], a[16:31]
    ds_read_b64_tr_b16 v[44:45], v190 offset:12288
    ds_read_b64_tr_b16 v[46:47], v191 offset:12288
    s_waitcnt lgkmcnt(10)
    v_mfma_f32_32x32x16_bf16 a[32:47], v[48:51], v[216:219], a[32:47]
    ds_read_b64_tr_b16 v[48:49], v184 offset:16384
    ds_read_b64_tr_b16 v[50:51], v185 offset:16384
    s_waitcnt lgkmcnt(10)
    v_mfma_f32_32x32x16_bf16 a[48:63], v[52:55], v[216:219], a[48:63]
    ds_read_b64_tr_b16 v[52:53], v186 offset:16384
    ds_read_b64_tr_b16 v[54:55], v187 offset:16384
    s_waitcnt lgkmcnt(10)
    v_mfma_f32_32x32x16_bf16 a[0:15], v[32:35], v[220:223], a[0:15]
    buffer_load_dwordx4 a[108:111], v5, s[56:59], s85 offen nt
    s_add_u32 s85, s85, 16384
    ds_read_b64_tr_b16 v[32:33], v188 offset:16384
    ds_read_b64_tr_b16 v[34:35], v189 offset:16384
    s_waitcnt lgkmcnt(10)
    v_mfma_f32_32x32x16_bf16 a[16:31], v[36:39], v[220:223], a[16:31]
    ds_read_b64_tr_b16 v[36:37], v190 offset:16384
    ds_read_b64_tr_b16 v[38:39], v191 offset:16384
    s_waitcnt lgkmcnt(10)
    v_mfma_f32_32x32x16_bf16 a[32:47], v[40:43], v[220:223], a[32:47]
    ds_read_b64_tr_b16 v[40:41], v184 offset:20480
    ds_read_b64_tr_b16 v[42:43], v185 offset:20480
    s_waitcnt lgkmcnt(10)
    v_mfma_f32_32x32x16_bf16 a[48:63], v[44:47], v[220:223], a[48:63]
    ds_read_b64_tr_b16 v[44:45], v186 offset:20480
    ds_read_b64_tr_b16 v[46:47], v187 offset:20480
    s_waitcnt lgkmcnt(10)
    v_mfma_f32_32x32x16_bf16 a[0:15], v[48:51], v[224:227], a[0:15]
    buffer_load_dwordx4 a[112:115], v5, s[56:59], s85 offen nt
    s_add_u32 s85, s85, 16384
    ds_read_b64_tr_b16 v[48:49], v188 offset:20480
    ds_read_b64_tr_b16 v[50:51], v189 offset:20480
    s_waitcnt lgkmcnt(10)
    v_mfma_f32_32x32x16_bf16 a[16:31], v[52:55], v[224:227], a[16:31]
    ds_read_b64_tr_b16 v[52:53], v190 offset:20480
    ds_read_b64_tr_b16 v[54:55], v191 offset:20480
    s_waitcnt lgkmcnt(10)
    v_mfma_f32_32x32x16_bf16 a[32:47], v[32:35], v[224:227], a[32:47]
    ds_read_b64_tr_b16 v[32:33], v184 offset:24576
    ds_read_b64_tr_b16 v[34:35], v185 offset:24576
    s_waitcnt lgkmcnt(10)
    v_mfma_f32_32x32x16_bf16 a[48:63], v[36:39], v[224:227], a[48:63]
    ds_read_b64_tr_b16 v[36:37], v186 offset:24576
    ds_read_b64_tr_b16 v[38:39], v187 offset:24576
    s_waitcnt lgkmcnt(10)
    v_mfma_f32_32x32x16_bf16 a[0:15], v[40:43], v[228:231], a[0:15]
    buffer_load_dwordx4 a[116:119], v5, s[56:59], s85 offen nt
    s_add_u32 s85, s85, 16384
    ds_read_b64_tr_b16 v[40:41], v188 offset:24576
    ds_read_b64_tr_b16 v[42:43], v189 offset:24576
    s_waitcnt lgkmcnt(10)
    v_mfma_f32_32x32x16_bf16 a[16:31], v[44:47], v[228:231], a[16:31]
    ds_read_b64_tr_b16 v[44:45], v190 offset:24576
    ds_read_b64_tr_b16 v[46:47], v191 offset:24576
    s_waitcnt lgkmcnt(10)
    v_mfma_f32_32x32x16_bf16 a[32:47], v[48:51], v[228:231], a[32:47]
    ds_read_b64_tr_b16 v[48:49], v184 offset:28672
    ds_read_b64_tr_b16 v[50:51], v185 offset:28672
    s_waitcnt lgkmcnt(10)
    v_mfma_f32_32x32x16_bf16 a[48:63], v[52:55], v[228:231], a[48:63]
    ds_read_b64_tr_b16 v[52:53], v186 offset:28672
    ds_read_b64_tr_b16 v[54:55], v187 offset:28672
    s_waitcnt lgkmcnt(10)
    v_mfma_f32_32x32x16_bf16 a[0:15], v[32:35], v[232:235], a[0:15]
    buffer_load_dwordx4 a[120:123], v5, s[56:59], s85 offen nt
    s_add_u32 s85, s85, 16384
    ds_read_b64_tr_b16 v[32:33], v188 offset:28672
    ds_read_b64_tr_b16 v[34:35], v189 offset:28672
    s_waitcnt lgkmcnt(10)
    v_mfma_f32_32x32x16_bf16 a[16:31], v[36:39], v[232:235], a[16:31]
    ds_read_b64_tr_b16 v[36:37], v190 offset:28672
    ds_read_b64_tr_b16 v[38:39], v191 offset:28672
    s_waitcnt lgkmcnt(10)
    v_mfma_f32_32x32x16_bf16 a[32:47], v[40:43], v[232:235], a[32:47]
    s_waitcnt lgkmcnt(8)
    v_mfma_f32_32x32x16_bf16 a[48:63], v[44:47], v[232:235], a[48:63]
    s_waitcnt lgkmcnt(6)
    v_mfma_f32_32x32x16_bf16 a[0:15], v[48:51], v[236:239], a[0:15]
    buffer_load_dwordx4 a[124:127], v5, s[56:59], s85 offen nt
    s_waitcnt lgkmcnt(4)
    v_mfma_f32_32x32x16_bf16 a[16:31], v[52:55], v[236:239], a[16:31]
    s_waitcnt lgkmcnt(2)
    v_mfma_f32_32x32x16_bf16 a[32:47], v[32:35], v[236:239], a[32:47]
    s_waitcnt lgkmcnt(0)
    v_mfma_f32_32x32x16_bf16 a[48:63], v[36:39], v[236:239], a[48:63]
    v_add_f32 v241, v24, v25
    v_add_f32 v26, v26, v27
    v_add_f32 v241, v241, v26
    s_nop 11
    v_and_b32 v16, 31, v1
    v_mul_u32_u24 v16, 272, v16
    v_lshrrev_b32 v17, 5, v1
    v_lshl_add_u32 v16, v17, 3, v16
    s_lshl_b32 s82, s78, 15
    v_add_u32 v16, s82, v16
    v_accvgpr_read_b32 v24, a0
    v_accvgpr_read_b32 v25, a1
    v_accvgpr_read_b32 v26, a2
    v_accvgpr_read_b32 v27, a3
    v_cvt_pk_bf16_f32 v24, v24, v25
    v_cvt_pk_bf16_f32 v25, v26, v27
    ds_write_b64 v16, v[24:25] offset:0
    v_accvgpr_read_b32 v28, a4
    v_accvgpr_read_b32 v29, a5
    v_accvgpr_read_b32 v30, a6
    v_accvgpr_read_b32 v31, a7
    v_cvt_pk_bf16_f32 v28, v28, v29
    v_cvt_pk_bf16_f32 v29, v30, v31
    ds_write_b64 v16, v[28:29] offset:16
    v_accvgpr_read_b32 v24, a8
    v_accvgpr_read_b32 v25, a9
    v_accvgpr_read_b32 v26, a10
    v_accvgpr_read_b32 v27, a11
    v_cvt_pk_bf16_f32 v24, v24, v25
    v_cvt_pk_bf16_f32 v25, v26, v27
    ds_write_b64 v16, v[24:25] offset:32
    v_accvgpr_read_b32 v28, a12
    v_accvgpr_read_b32 v29, a13
    v_accvgpr_read_b32 v30, a14
    v_accvgpr_read_b32 v31, a15
    v_cvt_pk_bf16_f32 v28, v28, v29
    v_cvt_pk_bf16_f32 v29, v30, v31
    ds_write_b64 v16, v[28:29] offset:48
    v_accvgpr_read_b32 v24, a16
    v_accvgpr_read_b32 v25, a17
    v_accvgpr_read_b32 v26, a18
    v_accvgpr_read_b32 v27, a19
    v_cvt_pk_bf16_f32 v24, v24, v25
    v_cvt_pk_bf16_f32 v25, v26, v27
    ds_write_b64 v16, v[24:25] offset:64
    v_accvgpr_read_b32 v28, a20
    v_accvgpr_read_b32 v29, a21
    v_accvgpr_read_b32 v30, a22
    v_accvgpr_read_b32 v31, a23
    v_cvt_pk_bf16_f32 v28, v28, v29
    v_cvt_pk_bf16_f32 v29, v30, v31
    ds_write_b64 v16, v[28:29] offset:80
    v_accvgpr_read_b32 v24, a24
    v_accvgpr_read_b32 v25, a25
    v_accvgpr_read_b32 v26, a26
    v_accvgpr_read_b32 v27, a27
    v_cvt_pk_bf16_f32 v24, v24, v25
    v_cvt_pk_bf16_f32 v25, v26, v27
    ds_write_b64 v16, v[24:25] offset:96
    v_accvgpr_read_b32 v28, a28
    v_accvgpr_read_b32 v29, a29
    v_accvgpr_read_b32 v30, a30
    v_accvgpr_read_b32 v31, a31
    v_cvt_pk_bf16_f32 v28, v28, v29
    v_cvt_pk_bf16_f32 v29, v30, v31
    ds_write_b64 v16, v[28:29] offset:112
    v_accvgpr_read_b32 v24, a32
    v_accvgpr_read_b32 v25, a33
    v_accvgpr_read_b32 v26, a34
    v_accvgpr_read_b32 v27, a35
    v_cvt_pk_bf16_f32 v24, v24, v25
    v_cvt_pk_bf16_f32 v25, v26, v27
    ds_write_b64 v16, v[24:25] offset:128
    v_accvgpr_read_b32 v28, a36
    v_accvgpr_read_b32 v29, a37
    v_accvgpr_read_b32 v30, a38
    v_accvgpr_read_b32 v31, a39
    v_cvt_pk_bf16_f32 v28, v28, v29
    v_cvt_pk_bf16_f32 v29, v30, v31
    ds_write_b64 v16, v[28:29] offset:144
    v_accvgpr_read_b32 v24, a40
    v_accvgpr_read_b32 v25, a41
    v_accvgpr_read_b32 v26, a42
    v_accvgpr_read_b32 v27, a43
    v_cvt_pk_bf16_f32 v24, v24, v25
    v_cvt_pk_bf16_f32 v25, v26, v27
    ds_write_b64 v16, v[24:25] offset:160
    v_accvgpr_read_b32 v28, a44
    v_accvgpr_read_b32 v29, a45
    v_accvgpr_read_b32 v30, a46
    v_accvgpr_read_b32 v31, a47
    v_cvt_pk_bf16_f32 v28, v28, v29
    v_cvt_pk_bf16_f32 v29, v30, v31
    ds_write_b64 v16, v[28:29] offset:176
    v_accvgpr_read_b32 v24, a48
    v_accvgpr_read_b32 v25, a49
    v_accvgpr_read_b32 v26, a50
    v_accvgpr_read_b32 v27, a51
    v_cvt_pk_bf16_f32 v24, v24, v25
    v_cvt_pk_bf16_f32 v25, v26, v27
    ds_write_b64 v16, v[24:25] offset:192
    v_accvgpr_read_b32 v28, a52
    v_accvgpr_read_b32 v29, a53
    v_accvgpr_read_b32 v30, a54
    v_accvgpr_read_b32 v31, a55
    v_cvt_pk_bf16_f32 v28, v28, v29
    v_cvt_pk_bf16_f32 v29, v30, v31
    ds_write_b64 v16, v[28:29] offset:208
    v_accvgpr_read_b32 v24, a56
    v_accvgpr_read_b32 v25, a57
    v_accvgpr_read_b32 v26, a58
    v_accvgpr_read_b32 v27, a59
    v_cvt_pk_bf16_f32 v24, v24, v25
    v_cvt_pk_bf16_f32 v25, v26, v27
    ds_write_b64 v16, v[24:25] offset:224
    v_accvgpr_read_b32 v28, a60
    v_accvgpr_read_b32 v29, a61
    v_accvgpr_read_b32 v30, a62
    v_accvgpr_read_b32 v31, a63
    v_cvt_pk_bf16_f32 v28, v28, v29
    v_cvt_pk_bf16_f32 v29, v30, v31
    ds_write_b64 v16, v[28:29] offset:240
    s_waitcnt lgkmcnt(0)
    v_mul_u32_u24 v17, 272, v2
    v_lshl_add_u32 v17, v3, 4, v17
    v_add_u32 v17, s82, v17
    ds_read_b128 v[96:99], v17 offset:0
    ds_read_b128 v[100:103], v17 offset:1088
    ds_read_b128 v[104:107], v17 offset:2176
    ds_read_b128 v[108:111], v17 offset:3264
    ds_read_b128 v[112:115], v17 offset:4352
    ds_read_b128 v[116:119], v17 offset:5440
    ds_read_b128 v[120:123], v17 offset:6528
    ds_read_b128 v[124:127], v17 offset:7616
    v_lshlrev_b32 v18, 10, v2
    v_lshl_add_u32 v18, v3, 4, v18
    s_lshl_b32 s82, s74, 22
    s_lshl_b32 s83, s39, 8
    s_add_u32 s82, s82, s83
    s_lshl_b32 s83, s75, 5
    s_add_u32 s83, s83, s73
    s_lshl_b32 s84, s83, 15
    s_add_u32 s82, s82, s84
    s_add_u32 s82, s82, 8388608
    s_waitcnt lgkmcnt(7)
    v_bfi_b32 v96, s3, v244, v96
    v_bfi_b32 v97, s3, v245, v97
    v_bfi_b32 v98, s3, v246, v98
    v_bfi_b32 v99, s3, v247, v99
    buffer_store_dwordx4 v[96:99], v18, s[64:67], s82 offen sc1
    s_add_u32 s82, s82, 4096
    s_waitcnt lgkmcnt(6)
    v_bfi_b32 v100, s3, v244, v100
    v_bfi_b32 v101, s3, v245, v101
    v_bfi_b32 v102, s3, v246, v102
    v_bfi_b32 v103, s3, v247, v103
    buffer_store_dwordx4 v[100:103], v18, s[64:67], s82 offen sc1
    s_add_u32 s82, s82, 4096
    s_waitcnt lgkmcnt(5)
    v_bfi_b32 v104, s3, v244, v104
    v_bfi_b32 v105, s3, v245, v105
    v_bfi_b32 v106, s3, v246, v106
    v_bfi_b32 v107, s3, v247, v107
    buffer_store_dwordx4 v[104:107], v18, s[64:67], s82 offen sc1
    s_add_u32 s82, s82, 4096
    s_waitcnt lgkmcnt(4)
    v_bfi_b32 v108, s3, v244, v108
    v_bfi_b32 v109, s3, v245, v109
    v_bfi_b32 v110, s3, v246, v110
    v_bfi_b32 v111, s3, v247, v111
    buffer_store_dwordx4 v[108:111], v18, s[64:67], s82 offen sc1
    s_add_u32 s82, s82, 4096
    s_waitcnt lgkmcnt(3)
    v_bfi_b32 v112, s3, v244, v112
    v_bfi_b32 v113, s3, v245, v113
    v_bfi_b32 v114, s3, v246, v114
    v_bfi_b32 v115, s3, v247, v115
    buffer_store_dwordx4 v[112:115], v18, s[64:67], s82 offen sc1
    s_add_u32 s82, s82, 4096
    s_waitcnt lgkmcnt(2)
    v_bfi_b32 v116, s3, v244, v116
    v_bfi_b32 v117, s3, v245, v117
    v_bfi_b32 v118, s3, v246, v118
    v_bfi_b32 v119, s3, v247, v119
    buffer_store_dwordx4 v[116:119], v18, s[64:67], s82 offen sc1
    s_add_u32 s82, s82, 4096
    s_waitcnt lgkmcnt(1)
    v_bfi_b32 v120, s3, v244, v120
    v_bfi_b32 v121, s3, v245, v121
    v_bfi_b32 v122, s3, v246, v122
    v_bfi_b32 v123, s3, v247, v123
    buffer_store_dwordx4 v[120:123], v18, s[64:67], s82 offen sc1
    s_add_u32 s82, s82, 4096
    s_waitcnt lgkmcnt(0)
    v_bfi_b32 v124, s3, v244, v124
    v_bfi_b32 v125, s3, v245, v125
    v_bfi_b32 v126, s3, v246, v126
    v_bfi_b32 v127, s3, v247, v127
    buffer_store_dwordx4 v[124:127], v18, s[64:67], s82 offen sc1
    v_lshlrev_b32 v19, 4, v1
    s_lshl_b32 s82, s74, 18
    s_lshl_b32 s84, s39, 9
    s_add_u32 s82, s82, s84
    s_lshl_b32 s84, s83, 11
    s_add_u32 s82, s82, s84
    s_add_u32 s82, s82, 4194304
    v_mov_b32 v248, v240
    v_mov_b32 v249, s80
    v_mov_b32 v250, v241
    v_mov_b32 v251, s80
    v_cmp_gt_u32 vcc, 32, v1
    s_and_saveexec_b64 s[90:91], vcc
    buffer_store_dwordx4 v[248:251], v19, s[64:67], s82 offen sc1
    s_mov_b64 exec, s[90:91]
    s_barrier
    s_lshl_b32 s82, s78, 10
    v_add_u32 v22, s82, v6
    s_waitcnt vmcnt(9)
    ds_write_b128 v22, a[64:67] offset:0
    ds_write_b128 v22, a[68:71] offset:4096
    ds_write_b128 v22, a[72:75] offset:8192
    ds_write_b128 v22, a[76:79] offset:12288
    ds_write_b128 v22, a[80:83] offset:16384
    ds_write_b128 v22, a[84:87] offset:20480
    ds_write_b128 v22, a[88:91] offset:24576
    ds_write_b128 v22, a[92:95] offset:28672
    ds_write_b128 v22, a[96:99] offset:32768
    ds_write_b128 v22, a[100:103] offset:36864
    ds_write_b128 v22, a[104:107] offset:40960
    ds_write_b128 v22, a[108:111] offset:45056
    ds_write_b128 v22, a[112:115] offset:49152
    ds_write_b128 v22, a[116:119] offset:53248
    ds_write_b128 v22, a[120:123] offset:57344
    ds_write_b128 v22, a[124:127] offset:61440
    s_waitcnt lgkmcnt(0)
    s_barrier
    v_add_u32 v16, 0, v8
    v_add_u32 v17, 0, v9
    v_add_u32 v18, 0, v10
    v_add_u32 v19, 0, v11
    ds_read_b64_tr_b16 v[208:209], v16 offset:0
    ds_read_b64_tr_b16 v[210:211], v17 offset:0
    ds_read_b64_tr_b16 v[212:213], v16 offset:8192
    ds_read_b64_tr_b16 v[214:215], v17 offset:8192
    ds_read_b64_tr_b16 v[216:217], v16 offset:16384
    ds_read_b64_tr_b16 v[218:219], v17 offset:16384
    ds_read_b64_tr_b16 v[220:221], v16 offset:24576
    ds_read_b64_tr_b16 v[222:223], v17 offset:24576
    ds_read_b64_tr_b16 v[224:225], v18 offset:0
    ds_read_b64_tr_b16 v[226:227], v19 offset:0
    ds_read_b64_tr_b16 v[228:229], v18 offset:8192
    ds_read_b64_tr_b16 v[230:231], v19 offset:8192
    ds_read_b64_tr_b16 v[232:233], v18 offset:16384
    ds_read_b64_tr_b16 v[234:235], v19 offset:16384
    ds_read_b64_tr_b16 v[236:237], v18 offset:24576
    ds_read_b64_tr_b16 v[238:239], v19 offset:24576
    v_add_u32 v24, 32768, v8
    v_add_u32 v25, 32768, v9
    v_add_u32 v26, 32768, v10
    v_add_u32 v27, 32768, v11
    ds_read_b64_tr_b16 v[160:161], v24 offset:0
    ds_read_b64_tr_b16 v[162:163], v25 offset:0
    ds_read_b64_tr_b16 v[164:165], v24 offset:8192
    ds_read_b64_tr_b16 v[166:167], v25 offset:8192
    ds_read_b64_tr_b16 v[168:169], v24 offset:16384
    ds_read_b64_tr_b16 v[170:171], v25 offset:16384
    ds_read_b64_tr_b16 v[172:173], v24 offset:24576
    ds_read_b64_tr_b16 v[174:175], v25 offset:24576
    ds_read_b64_tr_b16 v[176:177], v26 offset:0
    ds_read_b64_tr_b16 v[178:179], v27 offset:0
    ds_read_b64_tr_b16 v[180:181], v26 offset:8192
    ds_read_b64_tr_b16 v[182:183], v27 offset:8192
    ds_read_b64_tr_b16 v[184:185], v26 offset:16384
    ds_read_b64_tr_b16 v[186:187], v27 offset:16384
    ds_read_b64_tr_b16 v[188:189], v26 offset:24576
    ds_read_b64_tr_b16 v[190:191], v27 offset:24576
    s_lshl_b32 s84, s76, 18
    s_lshl_b32 s83, s78, 16
    s_add_u32 s84, s84, s83
    s_lshl_b32 s83, s77, 9
    s_add_u32 s84, s84, s83
    s_lshl_b32 s83, s7, 4
    s_add_u32 s84, s84, s83
    s_add_u32 s84, s84, 4194304
    s_lshl_b32 s82, s76, 22
    s_lshl_b32 s83, s78, 20
    s_add_u32 s82, s82, s83
    s_lshl_b32 s83, s7, 10
    s_add_u32 s82, s82, s83
    s_lshl_b32 s83, s77, 8
    s_add_u32 s82, s82, s83
    s_add_u32 s82, s82, 8388608
    v_lshlrev_b32 v21, 18, v2
    v_lshl_add_u32 v21, v3, 4, v21
    v_lshlrev_b32 v22, 14, v2
    s_waitcnt lgkmcnt(0)
    v_lshlrev_b32 v200, 3, v1
    s_lshl_b32 s98, s89, 13
    s_lshl_b32 s99, s78, 9
    s_add_u32 s98, s98, s99
    s_add_u32 s98, s98, 18350080
    s_add_u32 s99, s98, 4096
    buffer_load_dwordx2 v[192:193], v200, s[64:67], s98 offen offset:0 sc1
    buffer_load_dwordx2 v[194:195], v200, s[64:67], s98 offen offset:2048 sc1
    buffer_load_dwordx2 v[196:197], v200, s[64:67], s99 offen offset:0 sc1
    buffer_load_dwordx2 v[198:199], v200, s[64:67], s99 offen offset:2048 sc1
L_h2_15:
    s_add_u32 s100, s100, 1
    s_cmp_gt_u32 s100, 200000
    s_cbranch_scc1 L_end
    s_add_u32 s83, s84, 0
    buffer_load_dwordx4 v[32:35], v22, s[64:67], s83 offen offset:0 sc1
    buffer_load_dwordx4 v[36:39], v22, s[64:67], s83 offen offset:2048 sc1
    s_add_u32 s83, s84, 4096
    buffer_load_dwordx4 v[40:43], v22, s[64:67], s83 offen offset:0 sc1
    buffer_load_dwordx4 v[44:47], v22, s[64:67], s83 offen offset:2048 sc1
    s_add_u32 s83, s84, 8192
    buffer_load_dwordx4 v[48:51], v22, s[64:67], s83 offen offset:0 sc1
    buffer_load_dwordx4 v[52:55], v22, s[64:67], s83 offen offset:2048 sc1
    s_add_u32 s83, s84, 12288
    buffer_load_dwordx4 v[56:59], v22, s[64:67], s83 offen offset:0 sc1
    buffer_load_dwordx4 v[60:63], v22, s[64:67], s83 offen offset:2048 sc1
    s_waitcnt vmcnt(0)
    v_xor_b32 v30, s80, v33
    v_xor_b32 v31, s80, v35
    v_or_b32 v30, v30, v31
    v_xor_b32 v31, s80, v37
    v_or_b32 v30, v30, v31
    v_xor_b32 v31, s80, v39
    v_or_b32 v30, v30, v31
    v_xor_b32 v31, s80, v41
    v_or_b32 v30, v30, v31
    v_xor_b32 v31, s80, v43
    v_or_b32 v30, v30, v31
    v_xor_b32 v31, s80, v45
    v_or_b32 v30, v30, v31
    v_xor_b32 v31, s80, v47
    v_or_b32 v30, v30, v31
    v_xor_b32 v31, s80, v49
    v_or_b32 v30, v30, v31
    v_xor_b32 v31, s80, v51
    v_or_b32 v30, v30, v31
    v_xor_b32 v31, s80, v53
    v_or_b32 v30, v30, v31
    v_xor_b32 v31, s80, v55
    v_or_b32 v30, v30, v31
    v_xor_b32 v31, s80, v57
    v_or_b32 v30, v30, v31
    v_xor_b32 v31, s80, v59
    v_or_b32 v30, v30, v31
    v_xor_b32 v31, s80, v61
    v_or_b32 v30, v30, v31
    v_xor_b32 v31, s80, v63
    v_or_b32 v30, v30, v31
    v_cmp_ne_u32 vcc, 0, v30
    s_cbranch_vccnz L_h2_15
    s_add_u32 s83, s82, 0
    buffer_load_dwordx4 v[96:99], v21, s[64:67], s83 offen sc1
    s_add_u32 s83, s82, 32768
    buffer_load_dwordx4 v[100:103], v21, s[64:67], s83 offen sc1
    s_add_u32 s83, s82, 65536
    buffer_load_dwordx4 v[104:107], v21, s[64:67], s83 offen sc1
    s_add_u32 s83, s82, 98304
    buffer_load_dwordx4 v[108:111], v21, s[64:67], s83 offen sc1
    s_add_u32 s83, s82, 131072
    buffer_load_dwordx4 v[112:115], v21, s[64:67], s83 offen sc1
    s_add_u32 s83, s82, 163840
    buffer_load_dwordx4 v[116:119], v21, s[64:67], s83 offen sc1
    s_add_u32 s83, s82, 196608
    buffer_load_dwordx4 v[120:123], v21, s[64:67], s83 offen sc1
    s_add_u32 s83, s82, 229376
    buffer_load_dwordx4 v[124:127], v21, s[64:67], s83 offen sc1
    v_max3_f32 v24, v32, v36, v40
    v_max3_f32 v24, v24, v44, v48
    v_max3_f32 v24, v24, v52, v56
    v_max_f32 v24, v24, v60
    v_mov_b32 v25, v24
    s_nop 1
    v_permlane16_swap_b32 v24, v25
    s_nop 0
    v_max_f32 v24, v24, v25
    v_mov_b32 v25, v24
    s_nop 1
    v_permlane32_swap_b32 v24, v25
    s_nop 0
    v_max_f32 v24, v24, v25
    v_sub_f32 v32, v32, v24
    v_sub_f32 v36, v36, v24
    v_sub_f32 v40, v40, v24
    v_sub_f32 v44, v44, v24
    v_sub_f32 v48, v48, v24
    v_sub_f32 v52, v52, v24
    v_sub_f32 v56, v56, v24
    v_sub_f32 v60, v60, v24
    v_exp_f32 v32, v32
    v_exp_f32 v36, v36
    v_exp_f32 v40, v40
    v_exp_f32 v44, v44
    v_exp_f32 v48, v48
    v_exp_f32 v52, v52
    v_exp_f32 v56, v56
    v_exp_f32 v60, v60
    s_nop 0
    v_mul_f32 v26, v32, v34
    v_fmac_f32 v26, v36, v38
    v_fmac_f32 v26, v40, v42
    v_fmac_f32 v26, v44, v46
    v_fmac_f32 v26, v48, v50
    v_fmac_f32 v26, v52, v54
    v_fmac_f32 v26, v56, v58
    v_fmac_f32 v26, v60, v62
    v_mov_b32 v25, v26
    s_nop 1
    v_permlane16_swap_b32 v26, v25
    s_nop 0
    v_add_f32 v26, v26, v25
    v_mov_b32 v25, v26
    s_nop 1
    v_permlane32_swap_b32 v26, v25
    s_nop 0
    v_add_f32 v26, v26, v25
    v_rcp_f32 v26, v26
    s_nop 0
    v_mul_f32 v32, v32, v26
    v_mul_f32 v36, v36, v26
    v_mul_f32 v40, v40, v26
    v_mul_f32 v44, v44, v26
    v_mul_f32 v48, v48, v26
    v_mul_f32 v52, v52, v26
    v_mul_f32 v56, v56, v26
    v_mul_f32 v60, v60, v26
    v_mov_b32 v27, 0
    s_waitcnt vmcnt(7)
    v_xor_b32 v31, v96, v244
    v_or_b32 v27, v27, v31
    v_bfi_b32 v96, s3, 0, v96
    v_lshlrev_b32 v28, 16, v96
    v_and_b32 v29, s101, v96
    v_mul_f32 v64, v32, v28
    v_mul_f32 v65, v32, v29
    v_xor_b32 v31, v97, v245
    v_or_b32 v27, v27, v31
    v_bfi_b32 v97, s3, 0, v97
    v_lshlrev_b32 v28, 16, v97
    v_and_b32 v29, s101, v97
    v_mul_f32 v66, v32, v28
    v_mul_f32 v67, v32, v29
    v_xor_b32 v31, v98, v246
    v_or_b32 v27, v27, v31
    v_bfi_b32 v98, s3, 0, v98
    v_lshlrev_b32 v28, 16, v98
    v_and_b32 v29, s101, v98
    v_mul_f32 v68, v32, v28
    v_mul_f32 v69, v32, v29
    v_xor_b32 v31, v99, v247
    v_or_b32 v27, v27, v31
    v_bfi_b32 v99, s3, 0, v99
    v_lshlrev_b32 v28, 16, v99
    v_and_b32 v29, s101, v99
    v_mul_f32 v70, v32, v28
    v_mul_f32 v71, v32, v29
    s_waitcnt vmcnt(6)
    v_xor_b32 v31, v100, v244
    v_or_b32 v27, v27, v31
    v_bfi_b32 v100, s3, 0, v100
    v_lshlrev_b32 v28, 16, v100
    v_and_b32 v29, s101, v100
    v_fmac_f32 v64, v36, v28
    v_fmac_f32 v65, v36, v29
    v_xor_b32 v31, v101, v245
    v_or_b32 v27, v27, v31
    v_bfi_b32 v101, s3, 0, v101
    v_lshlrev_b32 v28, 16, v101
    v_and_b32 v29, s101, v101
    v_fmac_f32 v66, v36, v28
    v_fmac_f32 v67, v36, v29
    v_xor_b32 v31, v102, v246
    v_or_b32 v27, v27, v31
    v_bfi_b32 v102, s3, 0, v102
    v_lshlrev_b32 v28, 16, v102
    v_and_b32 v29, s101, v102
    v_fmac_f32 v68, v36, v28
    v_fmac_f32 v69, v36, v29
    v_xor_b32 v31, v103, v247
    v_or_b32 v27, v27, v31
    v_bfi_b32 v103, s3, 0, v103
    v_lshlrev_b32 v28, 16, v103
    v_and_b32 v29, s101, v103
    v_fmac_f32 v70, v36, v28
    v_fmac_f32 v71, v36, v29
    s_waitcnt vmcnt(5)
    v_xor_b32 v31, v104, v244
    v_or_b32 v27, v27, v31
    v_bfi_b32 v104, s3, 0, v104
    v_lshlrev_b32 v28, 16, v104
    v_and_b32 v29, s101, v104
    v_fmac_f32 v64, v40, v28
    v_fmac_f32 v65, v40, v29
    v_xor_b32 v31, v105, v245
    v_or_b32 v27, v27, v31
    v_bfi_b32 v105, s3, 0, v105
    v_lshlrev_b32 v28, 16, v105
    v_and_b32 v29, s101, v105
    v_fmac_f32 v66, v40, v28
    v_fmac_f32 v67, v40, v29
    v_xor_b32 v31, v106, v246
    v_or_b32 v27, v27, v31
    v_bfi_b32 v106, s3, 0, v106
    v_lshlrev_b32 v28, 16, v106
    v_and_b32 v29, s101, v106
    v_fmac_f32 v68, v40, v28
    v_fmac_f32 v69, v40, v29
    v_xor_b32 v31, v107, v247
    v_or_b32 v27, v27, v31
    v_bfi_b32 v107, s3, 0, v107
    v_lshlrev_b32 v28, 16, v107
    v_and_b32 v29, s101, v107
    v_fmac_f32 v70, v40, v28
    v_fmac_f32 v71, v40, v29
    s_waitcnt vmcnt(4)
    v_xor_b32 v31, v108, v244
    v_or_b32 v27, v27, v31
    v_bfi_b32 v108, s3, 0, v108
    v_lshlrev_b32 v28, 16, v108
    v_and_b32 v29, s101, v108
    v_fmac_f32 v64, v44, v28
    v_fmac_f32 v65, v44, v29
    v_xor_b32 v31, v109, v245
    v_or_b32 v27, v27, v31
    v_bfi_b32 v109, s3, 0, v109
    v_lshlrev_b32 v28, 16, v109
    v_and_b32 v29, s101, v109
    v_fmac_f32 v66, v44, v28
    v_fmac_f32 v67, v44, v29
    v_xor_b32 v31, v110, v246
    v_or_b32 v27, v27, v31
    v_bfi_b32 v110, s3, 0, v110
    v_lshlrev_b32 v28, 16, v110
    v_and_b32 v29, s101, v110
    v_fmac_f32 v68, v44, v28
    v_fmac_f32 v69, v44, v29
    v_xor_b32 v31, v111, v247
    v_or_b32 v27, v27, v31
    v_bfi_b32 v111, s3, 0, v111
    v_lshlrev_b32 v28, 16, v111
    v_and_b32 v29, s101, v111
    v_fmac_f32 v70, v44, v28
    v_fmac_f32 v71, v44, v29
    s_waitcnt vmcnt(3)
    v_xor_b32 v31, v112, v244
    v_or_b32 v27, v27, v31
    v_bfi_b32 v112, s3, 0, v112
    v_lshlrev_b32 v28, 16, v112
    v_and_b32 v29, s101, v112
    v_fmac_f32 v64, v48, v28
    v_fmac_f32 v65, v48, v29
    v_xor_b32 v31, v113, v245
    v_or_b32 v27, v27, v31
    v_bfi_b32 v113, s3, 0, v113
    v_lshlrev_b32 v28, 16, v113
    v_and_b32 v29, s101, v113
    v_fmac_f32 v66, v48, v28
    v_fmac_f32 v67, v48, v29
    v_xor_b32 v31, v114, v246
    v_or_b32 v27, v27, v31
    v_bfi_b32 v114, s3, 0, v114
    v_lshlrev_b32 v28, 16, v114
    v_and_b32 v29, s101, v114
    v_fmac_f32 v68, v48, v28
    v_fmac_f32 v69, v48, v29
    v_xor_b32 v31, v115, v247
    v_or_b32 v27, v27, v31
    v_bfi_b32 v115, s3, 0, v115
    v_lshlrev_b32 v28, 16, v115
    v_and_b32 v29, s101, v115
    v_fmac_f32 v70, v48, v28
    v_fmac_f32 v71, v48, v29
    s_waitcnt vmcnt(2)
    v_xor_b32 v31, v116, v244
    v_or_b32 v27, v27, v31
    v_bfi_b32 v116, s3, 0, v116
    v_lshlrev_b32 v28, 16, v116
    v_and_b32 v29, s101, v116
    v_fmac_f32 v64, v52, v28
    v_fmac_f32 v65, v52, v29
    v_xor_b32 v31, v117, v245
    v_or_b32 v27, v27, v31
    v_bfi_b32 v117, s3, 0, v117
    v_lshlrev_b32 v28, 16, v117
    v_and_b32 v29, s101, v117
    v_fmac_f32 v66, v52, v28
    v_fmac_f32 v67, v52, v29
    v_xor_b32 v31, v118, v246
    v_or_b32 v27, v27, v31
    v_bfi_b32 v118, s3, 0, v118
    v_lshlrev_b32 v28, 16, v118
    v_and_b32 v29, s101, v118
    v_fmac_f32 v68, v52, v28
    v_fmac_f32 v69, v52, v29
    v_xor_b32 v31, v119, v247
    v_or_b32 v27, v27, v31
    v_bfi_b32 v119, s3, 0, v119
    v_lshlrev_b32 v28, 16, v119
    v_and_b32 v29, s101, v119
    v_fmac_f32 v70, v52, v28
    v_fmac_f32 v71, v52, v29
    s_waitcnt vmcnt(1)
    v_xor_b32 v31, v120, v244
    v_or_b32 v27, v27, v31
    v_bfi_b32 v120, s3, 0, v120
    v_lshlrev_b32 v28, 16, v120
    v_and_b32 v29, s101, v120
    v_fmac_f32 v64, v56, v28
    v_fmac_f32 v65, v56, v29
    v_xor_b32 v31, v121, v245
    v_or_b32 v27, v27, v31
    v_bfi_b32 v121, s3, 0, v121
    v_lshlrev_b32 v28, 16, v121
    v_and_b32 v29, s101, v121
    v_fmac_f32 v66, v56, v28
    v_fmac_f32 v67, v56, v29
    v_xor_b32 v31, v122, v246
    v_or_b32 v27, v27, v31
    v_bfi_b32 v122, s3, 0, v122
    v_lshlrev_b32 v28, 16, v122
    v_and_b32 v29, s101, v122
    v_fmac_f32 v68, v56, v28
    v_fmac_f32 v69, v56, v29
    v_xor_b32 v31, v123, v247
    v_or_b32 v27, v27, v31
    v_bfi_b32 v123, s3, 0, v123
    v_lshlrev_b32 v28, 16, v123
    v_and_b32 v29, s101, v123
    v_fmac_f32 v70, v56, v28
    v_fmac_f32 v71, v56, v29
    s_waitcnt vmcnt(0)
    v_xor_b32 v31, v124, v244
    v_or_b32 v27, v27, v31
    v_bfi_b32 v124, s3, 0, v124
    v_lshlrev_b32 v28, 16, v124
    v_and_b32 v29, s101, v124
    v_fmac_f32 v64, v60, v28
    v_fmac_f32 v65, v60, v29
    v_xor_b32 v31, v125, v245
    v_or_b32 v27, v27, v31
    v_bfi_b32 v125, s3, 0, v125
    v_lshlrev_b32 v28, 16, v125
    v_and_b32 v29, s101, v125
    v_fmac_f32 v66, v60, v28
    v_fmac_f32 v67, v60, v29
    v_xor_b32 v31, v126, v246
    v_or_b32 v27, v27, v31
    v_bfi_b32 v126, s3, 0, v126
    v_lshlrev_b32 v28, 16, v126
    v_and_b32 v29, s101, v126
    v_fmac_f32 v68, v60, v28
    v_fmac_f32 v69, v60, v29
    v_xor_b32 v31, v127, v247
    v_or_b32 v27, v27, v31
    v_bfi_b32 v127, s3, 0, v127
    v_lshlrev_b32 v28, 16, v127
    v_and_b32 v29, s101, v127
    v_fmac_f32 v70, v60, v28
    v_fmac_f32 v71, v60, v29
    v_and_or_b32 v30, v27, s3, v30
    v_cmp_ne_u32 vcc, 0, v30
    s_cbranch_vccnz L_h2_15
    v_mov_b32 v72, v64
    v_mov_b32 v73, v65
    v_mov_b32 v74, v66
    v_mov_b32 v75, v67
    v_mov_b32 v76, v68
    v_mov_b32 v77, v69
    v_mov_b32 v78, v70
    v_mov_b32 v79, v71
    s_nop 1
    v_permlane16_swap_b32 v64, v72
    v_permlane16_swap_b32 v65, v73
    v_permlane16_swap_b32 v66, v74
    v_permlane16_swap_b32 v67, v75
    v_permlane16_swap_b32 v68, v76
    v_permlane16_swap_b32 v69, v77
    v_permlane16_swap_b32 v70, v78
    v_permlane16_swap_b32 v71, v79
    s_nop 0
    v_add_f32 v64, v64, v72
    v_add_f32 v65, v65, v73
    v_add_f32 v66, v66, v74
    v_add_f32 v67, v67, v75
    v_add_f32 v68, v68, v76
    v_add_f32 v69, v69, v77
    v_add_f32 v70, v70, v78
    v_add_f32 v71, v71, v79
    v_mov_b32 v72, v64
    v_mov_b32 v73, v65
    v_mov_b32 v74, v66
    v_mov_b32 v75, v67
    v_mov_b32 v76, v68
    v_mov_b32 v77, v69
    v_mov_b32 v78, v70
    v_mov_b32 v79, v71
    s_nop 1
    v_permlane32_swap_b32 v64, v72
    v_permlane32_swap_b32 v65, v73
    v_permlane32_swap_b32 v66, v74
    v_permlane32_swap_b32 v67, v75
    v_permlane32_swap_b32 v68, v76
    v_permlane32_swap_b32 v69, v77
    v_permlane32_swap_b32 v70, v78
    v_permlane32_swap_b32 v71, v79
    s_nop 0
    v_add_f32 v64, v64, v72
    v_add_f32 v65, v65, v73
    v_add_f32 v66, v66, v74
    v_add_f32 v67, v67, v75
    v_add_f32 v68, v68, v76
    v_add_f32 v69, v69, v77
    v_add_f32 v70, v70, v78
    v_add_f32 v71, v71, v79
    v_cvt_pk_bf16_f32 v24, v64, v65
    v_cvt_pk_bf16_f32 v25, v66, v67
    v_cvt_pk_bf16_f32 v26, v68, v69
    v_cvt_pk_bf16_f32 v27, v70, v71
    s_lshl_b32 s83, s78, 8
    s_add_u32 s83, s83, 147456
    v_lshl_add_u32 v21, v3, 4, s83
    ds_write_b128 v21, v[24:27]
    s_waitcnt lgkmcnt(0)
    s_barrier
    v_add_u32 v20, 147456, v12
    ds_read_b128 v[64:67], v20 offset:0
    ds_read_b128 v[68:71], v20 offset:64
    ds_read_b128 v[72:75], v20 offset:128
    ds_read_b128 v[76:79], v20 offset:192
    v_mov_b32 v80, 0
    v_mov_b32 v81, 0
    v_mov_b32 v82, 0
    v_mov_b32 v83, 0
    v_mov_b32 v84, 0
    v_mov_b32 v85, 0
    v_mov_b32 v86, 0
    v_mov_b32 v87, 0
    s_waitcnt lgkmcnt(0)
    s_nop 0
    v_mfma_f32_16x16x32_bf16 v[80:83], v[208:211], v[64:67], v[80:83]
    v_mfma_f32_16x16x32_bf16 v[84:87], v[224:227], v[64:67], v[84:87]
    v_mfma_f32_16x16x32_bf16 v[80:83], v[212:215], v[68:71], v[80:83]
    v_mfma_f32_16x16x32_bf16 v[84:87], v[228:231], v[68:71], v[84:87]
    v_mfma_f32_16x16x32_bf16 v[80:83], v[216:219], v[72:75], v[80:83]
    v_mfma_f32_16x16x32_bf16 v[84:87], v[232:235], v[72:75], v[84:87]
    v_mfma_f32_16x16x32_bf16 v[80:83], v[220:223], v[76:79], v[80:83]
    v_mfma_f32_16x16x32_bf16 v[84:87], v[236:239], v[76:79], v[84:87]
    s_nop 9
    s_add_u32 s84, s97, 17825792
    v_mov_b32_dpp v80, v84 row_shr:4 row_mask:0xf bank_mask:0x2
    v_mov_b32_dpp v81, v85 row_shr:4 row_mask:0xf bank_mask:0x2
    v_mov_b32_dpp v82, v86 row_shr:4 row_mask:0xf bank_mask:0x2
    v_mov_b32_dpp v83, v87 row_shr:4 row_mask:0xf bank_mask:0x2
    v_cvt_pk_bf16_f32 v22, v80, v81
    v_lshl_or_b32 v252, v22, 16, v7
    v_and_or_b32 v253, v22, s101, v7
    v_cvt_pk_bf16_f32 v23, v82, v83
    v_lshl_or_b32 v254, v23, 16, v7
    v_and_or_b32 v255, v23, s101, v7
    s_mov_b32 s10, s84
    s_add_u32 s82, s84, 524288
    v_cmp_gt_u32 vcc, 8, v3
    s_and_saveexec_b64 s[90:91], vcc
    buffer_store_dwordx4 v[252:255], v13, s[64:67], s82 offen
    s_mov_b64 exec, s[90:91]
    s_add_u32 s84, s96, 17825792
    v_lshlrev_b32 v21, 3, v1
    s_lshl_b32 s83, s78, 9
    s_add_u32 s83, s83, s84
    s_add_u32 s85, s83, 4096
    s_add_u32 s82, s83, 524288
    s_add_u32 s84, s85, 524288
    s_mov_b32 s6, 0
L_g4_16:
    s_add_u32 s100, s100, 1
    s_cmp_gt_u32 s100, 200000
    s_cbranch_scc1 L_end
    buffer_load_dwordx2 v[96:97], v21, s[64:67], s82 offen offset:0 sc1
    buffer_load_dwordx2 v[98:99], v21, s[64:67], s82 offen offset:2048 sc1
    buffer_load_dwordx2 v[100:101], v21, s[64:67], s84 offen offset:0 sc1
    buffer_load_dwordx2 v[102:103], v21, s[64:67], s84 offen offset:2048 sc1
    s_waitcnt vmcnt(0)
    v_xor_b32 v22, v96, v7
    v_xor_b32 v23, v97, v7
    v_or_b32 v22, v22, v23
    v_xor_b32 v23, v98, v7
    v_or_b32 v22, v22, v23
    v_xor_b32 v23, v99, v7
    v_or_b32 v22, v22, v23
    v_xor_b32 v23, v100, v7
    v_or_b32 v22, v22, v23
    v_xor_b32 v23, v101, v7
    v_or_b32 v22, v22, v23
    v_xor_b32 v23, v102, v7
    v_or_b32 v22, v22, v23
    v_xor_b32 v23, v103, v7
    v_or_b32 v22, v22, v23
    v_and_b32 v22, 0xffff, v22
    v_cmp_ne_u32 vcc, 0, v22
    s_cbranch_vccz L_g4ok_17
    s_add_u32 s6, s6, 1
    s_and_b32 s98, s6, 31
    s_cbranch_scc1 L_g4_16
    v_cmp_gt_u32 vcc, 8, v3
    s_and_saveexec_b64 s[90:91], vcc
    buffer_store_dwordx4 v[252:255], v13, s[64:67], s10 offen sc1
    s_mov_b64 exec, s[90:91]
    buffer_load_dwordx2 v[96:97], v21, s[64:67], s83 offen offset:0 sc1
    buffer_load_dwordx2 v[98:99], v21, s[64:67], s83 offen offset:2048 sc1
    buffer_load_dwordx2 v[100:101], v21, s[64:67], s85 offen offset:0 sc1
    buffer_load_dwordx2 v[102:103], v21, s[64:67], s85 offen offset:2048 sc1
    s_waitcnt vmcnt(0)
    v_xor_b32 v22, v96, v7
    v_xor_b32 v23, v97, v7
    v_or_b32 v22, v22, v23
    v_xor_b32 v23, v98, v7
    v_or_b32 v22, v22, v23
    v_xor_b32 v23, v99, v7
    v_or_b32 v22, v22, v23
    v_xor_b32 v23, v100, v7
    v_or_b32 v22, v22, v23
    v_xor_b32 v23, v101, v7
    v_or_b32 v22, v22, v23
    v_xor_b32 v23, v102, v7
    v_or_b32 v22, v22, v23
    v_xor_b32 v23, v103, v7
    v_or_b32 v22, v22, v23
    v_and_b32 v22, 0xffff, v22
    v_cmp_ne_u32 vcc, 0, v22
    s_cbranch_vccnz L_g4_16
L_g4ok_17:
    v_cmp_gt_u32 vcc, 8, v3
    s_and_saveexec_b64 s[90:91], vcc
    buffer_store_dwordx4 v[252:255], v13, s[64:67], s10 offen sc1
    s_mov_b64 exec, s[90:91]
    v_and_b32 v96, s101, v96
    v_and_b32 v98, s101, v98
    v_and_b32 v100, s101, v100
    v_and_b32 v102, s101, v102
    v_add_f32 v24, v96, v98
    v_add_f32 v26, v100, v102
    v_add_f32 v24, v24, v26
    v_and_b32 v97, s101, v97
    v_and_b32 v99, s101, v99
    v_and_b32 v101, s101, v101
    v_and_b32 v103, s101, v103
    v_add_f32 v25, v97, v99
    v_add_f32 v27, v101, v103
    v_add_f32 v25, v25, v27
    v_cvt_pk_bf16_f32 v24, v24, v25
    s_lshl_b32 s83, s78, 8
    s_add_u32 s83, s83, 148480
    v_lshl_add_u32 v21, v1, 2, s83
    ds_write_b32 v21, v24
    s_waitcnt lgkmcnt(0)
    s_barrier
    v_add_u32 v20, 148480, v12
    ds_read_b128 v[64:67], v20 offset:0
    ds_read_b128 v[68:71], v20 offset:64
    ds_read_b128 v[72:75], v20 offset:128
    ds_read_b128 v[76:79], v20 offset:192
    v_mov_b32 v80, 0
    v_mov_b32 v81, 0
    v_mov_b32 v82, 0
    v_mov_b32 v83, 0
    v_mov_b32 v84, 0
    v_mov_b32 v85, 0
    v_mov_b32 v86, 0
    v_mov_b32 v87, 0
    s_waitcnt lgkmcnt(0)
    s_nop 0
    v_mfma_f32_16x16x32_bf16 v[80:83], v[160:163], v[64:67], v[80:83]
    v_mfma_f32_16x16x32_bf16 v[84:87], v[176:179], v[64:67], v[84:87]
    v_mfma_f32_16x16x32_bf16 v[80:83], v[164:167], v[68:71], v[80:83]
    v_mfma_f32_16x16x32_bf16 v[84:87], v[180:183], v[68:71], v[84:87]
    v_mfma_f32_16x16x32_bf16 v[80:83], v[168:171], v[72:75], v[80:83]
    v_mfma_f32_16x16x32_bf16 v[84:87], v[184:187], v[72:75], v[84:87]
    v_mfma_f32_16x16x32_bf16 v[80:83], v[172:175], v[76:79], v[80:83]
    v_mfma_f32_16x16x32_bf16 v[84:87], v[188:191], v[76:79], v[84:87]
    s_nop 9
    v_and_b32 v13, 3, v3
    v_lshlrev_b32 v13, 14, v13
    v_lshl_add_u32 v13, v2, 4, v13
    v_lshrrev_b32 v22, 2, v3
    v_lshl_add_u32 v13, v22, 11, v13
    s_lshl_b32 s82, s76, 18
    s_lshl_b32 s83, s77, 16
    s_add_u32 s82, s82, s83
    s_lshl_b32 s83, s78, 12
    s_add_u32 s82, s82, s83
    s_lshl_b32 s83, s7, 6
    s_add_u32 s82, s82, s83
    s_add_u32 s84, s82, 3145728
    v_mov_b32_dpp v80, v84 row_shr:4 row_mask:0xf bank_mask:0x2
    v_mov_b32_dpp v81, v85 row_shr:4 row_mask:0xf bank_mask:0x2
    v_mov_b32_dpp v82, v86 row_shr:4 row_mask:0xf bank_mask:0x2
    v_mov_b32_dpp v83, v87 row_shr:4 row_mask:0xf bank_mask:0x2
    v_cvt_pk_bf16_f32 v22, v80, v81
    v_lshl_or_b32 v252, v22, 16, v7
    v_and_or_b32 v253, v22, s101, v7
    v_cvt_pk_bf16_f32 v23, v82, v83
    v_lshl_or_b32 v254, v23, 16, v7
    v_and_or_b32 v255, v23, s101, v7
    s_mov_b32 s10, s84
    v_cmp_gt_u32 vcc, 8, v3
    s_and_saveexec_b64 s[90:91], vcc
    buffer_store_dwordx4 v[252:255], v13, s[64:67], s10 offen sc1
    s_mov_b64 exec, s[90:91]
    s_cmp_lg_u32 s78, 0
    s_cbranch_scc1 L_end
    s_lshl_b32 s82, s72, 16
    s_lshl_b32 s83, s73, 11
    s_add_u32 s82, s82, s83
    s_add_u32 s82, s82, 3145728
L_h4_18:
    s_add_u32 s100, s100, 1
    s_cmp_gt_u32 s100, 200000
    s_cbranch_scc1 L_end
    buffer_load_dwordx4 v[96:99], v6, s[64:67], s82 offen sc1
    buffer_load_dwordx4 v[100:103], v6, s[64:67], s82 offen offset:1024 sc1
    s_waitcnt vmcnt(0)
    v_xor_b32 v22, v96, v7
    v_xor_b32 v23, v97, v7
    v_or_b32 v22, v22, v23
    v_xor_b32 v23, v98, v7
    v_or_b32 v22, v22, v23
    v_xor_b32 v23, v99, v7
    v_or_b32 v22, v22, v23
    v_xor_b32 v23, v100, v7
    v_or_b32 v22, v22, v23
    v_xor_b32 v23, v101, v7
    v_or_b32 v22, v22, v23
    v_xor_b32 v23, v102, v7
    v_or_b32 v22, v22, v23
    v_xor_b32 v23, v103, v7
    v_or_b32 v22, v22, v23
    v_and_b32 v22, 0xffff, v22
    v_cmp_ne_u32 vcc, 0, v22
    s_cbranch_vccnz L_h4_18
    v_and_b32 v96, s101, v96
    v_and_b32 v97, s101, v97
    v_and_b32 v98, s101, v98
    v_and_b32 v99, s101, v99
    v_and_b32 v100, s101, v100
    v_and_b32 v101, s101, v101
    v_and_b32 v102, s101, v102
    v_and_b32 v103, s101, v103
    v_add_f32 v96, v96, v100
    v_add_f32 v97, v97, v101
    v_add_f32 v98, v98, v102
    v_add_f32 v99, v99, v103
    s_nop 1
    v_add_f32_dpp v100, v96, v96 row_ror:4 row_mask:0xf bank_mask:0xf
    v_add_f32_dpp v101, v97, v97 row_ror:4 row_mask:0xf bank_mask:0xf
    v_add_f32_dpp v102, v98, v98 row_ror:4 row_mask:0xf bank_mask:0xf
    v_add_f32_dpp v103, v99, v99 row_ror:4 row_mask:0xf bank_mask:0xf
    s_nop 1
    v_add_f32_dpp v96, v100, v100 row_ror:8 row_mask:0xf bank_mask:0xf
    v_add_f32_dpp v97, v101, v101 row_ror:8 row_mask:0xf bank_mask:0xf
    v_add_f32_dpp v98, v102, v102 row_ror:8 row_mask:0xf bank_mask:0xf
    v_add_f32_dpp v99, v103, v103 row_ror:8 row_mask:0xf bank_mask:0xf
    v_mov_b32 v100, v96
    v_mov_b32 v101, v97
    v_mov_b32 v102, v98
    v_mov_b32 v103, v99
    s_nop 1
    v_permlane16_swap_b32 v96, v100
    v_permlane16_swap_b32 v97, v101
    v_permlane16_swap_b32 v98, v102
    v_permlane16_swap_b32 v99, v103
    s_nop 0
    v_add_f32 v96, v96, v100
    v_add_f32 v97, v97, v101
    v_add_f32 v98, v98, v102
    v_add_f32 v99, v99, v103
    v_mov_b32 v100, v96
    v_mov_b32 v101, v97
    v_mov_b32 v102, v98
    v_mov_b32 v103, v99
    s_nop 1
    v_permlane32_swap_b32 v96, v100
    v_permlane32_swap_b32 v97, v101
    v_permlane32_swap_b32 v98, v102
    v_permlane32_swap_b32 v99, v103
    s_nop 0
    v_add_f32 v96, v96, v100
    v_add_f32 v97, v97, v101
    v_add_f32 v98, v98, v102
    v_add_f32 v99, v99, v103
    v_cvt_pk_bf16_f32 v24, v96, v97
    v_cvt_pk_bf16_f32 v25, v98, v99
    s_lshr_b32 s82, s73, 3
    s_lshl_b32 s82, s82, 11
    s_lshl_b32 s83, s74, 10
    s_add_u32 s82, s82, s83
    s_lshl_b32 s83, s75, 8
    s_add_u32 s82, s82, s83
    s_and_b32 s83, s73, 7
    s_lshl_b32 s83, s83, 5
    s_add_u32 s82, s82, s83
    v_lshlrev_b32 v21, 3, v1
    v_cmp_gt_u32 vcc, 4, v1
    s_and_saveexec_b64 s[90:91], vcc
    buffer_store_dwordx2 v[24:25], v21, s[68:71], s82 offen
    s_mov_b64 exec, s[90:91]
    s_cmp_lg_u32 s2, 0
    s_cbranch_scc1 L_ep_19
    v_mov_b32 v20, s80
    v_mov_b32 v21, 0
    v_cmp_eq_u32 vcc, 0, v1
    s_and_saveexec_b64 s[90:91], vcc
    buffer_store_dword v20, v21, s[64:67], 0 offen sc1
    s_mov_b64 exec, s[90:91]
L_ep_19:
L_end:
    s_endpgm
.section .rodata,"a"
.p2align 6
.amdhsa_kernel concat_heads__compressed_kv_cla__compressed_kv_cla__decode_kernel
  .amdhsa_next_free_vgpr 512
  .amdhsa_next_free_sgpr 102
  .amdhsa_accum_offset 256
  .amdhsa_group_segment_fixed_size 0
  .amdhsa_kernarg_size 120
  .amdhsa_user_sgpr_count 2
  .amdhsa_user_sgpr_kernarg_segment_ptr 1
  .amdhsa_system_sgpr_workgroup_id_x 1
.end_amdhsa_kernel
```
